```python
import torch

def _softmax(x, axis=-1):
    return torch.softmax(x, dim=axis)
def _gelu(x):
    return torch.nn.functional.gelu(x, approximate="tanh")
def _silu(x):
    return torch.nn.functional.silu(x)
def _sigmoid(x):
    return torch.sigmoid(x)
def _layernorm(x, axis=-1, eps=1e-5):
    m = x.mean(dim=axis, keepdim=True)
    v = x.var(dim=axis, keepdim=True, unbiased=False)
    return (x - m) / torch.sqrt(v + eps)
def _scatter_add(tgt, idx, src, axis=0):
    return tgt.clone().index_add_(axis, idx, src)
def _segment_sum(src, seg, n):
    out = torch.zeros((n,) + src.shape[1:], dtype=src.dtype)
    return out.index_add_(0, seg, src)
def _pad(x, pw):
    flat = tuple(v for pair in reversed(pw) for v in pair)
    return torch.nn.functional.pad(x, flat)

kernel_name = 'parallel_sum__sliding_block_cached__glu_gated_geglu__decode'

def setup_inputs():

    _w = (lambda a: (lambda t: t.to(torch.bfloat16) if t.is_floating_point() else t)(torch.as_tensor(a)))
    def _A_setup():
        B, Sq, D = 2, 1, 448
        Hq, Hkv, Sk, Dh = 16, 8, 32768, 256
        assert Hq % Hkv == 0, (Hq, Hkv)
        return {
            "x": _w((lambda *s: torch.randn(*s, dtype=torch.bfloat16) * 0.05)(B, Sq, D)),
            "k_cache": _w((lambda *s: torch.randn(*s, dtype=torch.bfloat16) * 1.6)(B, Hkv, Sk, Dh)),
            "v_cache": _w((lambda *s: torch.randn(*s, dtype=torch.bfloat16) * 0.8)(B, Hkv, Sk, Dh)),
            "wq": _w((lambda *s: torch.randn(*s, dtype=torch.bfloat16) * 1.6)(D, Hq * Dh) * (D ** -0.5)),
            "wo": _w((lambda *s: torch.randn(*s, dtype=torch.bfloat16) * 0.8)(Hq * Dh, D) * ((Hq * Dh) ** -0.5)),
        }
    _A_in = _A_setup()

    def _B_setup():
        B, S, Dm, Df = 2, 1, 448, 1792
        return {
            "x": _w((lambda *s: torch.randn(*s, dtype=torch.bfloat16) * 0.05)(B, S, Dm)),
            "w_gate": _w((lambda *s: torch.randn(*s, dtype=torch.bfloat16) * 0.4)(Dm, Df) * (Dm ** -0.5)),
            "w_up": _w((lambda *s: torch.randn(*s, dtype=torch.bfloat16) * 0.4)(Dm, Df) * (Dm ** -0.5)),
            "w_down": _w((lambda *s: torch.randn(*s, dtype=torch.bfloat16) * 0.4)(Df, Dm) * (Df ** -0.5)),
        }
    _B_in = _B_setup()

    return {
        "A_x": _A_in["x"],
        "A_k_cache": _A_in["k_cache"],
        "A_v_cache": _A_in["v_cache"],
        "A_wq": _A_in["wq"],
        "A_wo": _A_in["wo"],
        "B_x": _B_in["x"],
        "B_w_gate": _B_in["w_gate"],
        "B_w_up": _B_in["w_up"],
        "B_w_down": _B_in["w_down"],
    }

def reference(A_x, A_k_cache, A_v_cache, A_wq, A_wo, B_x, B_w_gate, B_w_up, B_w_down):
    def _A_ref(x, k_cache, v_cache, wq, wo):
        B, Sq, D = x.shape
        Hq, Dh = 16, 256
        Hkv, Sk = k_cache.shape[1], k_cache.shape[2]
        W = min(4096, max(256, Sk // 4))
        rep = Hq // Hkv
        q = (lambda x, *d: x.permute(*d))((x @ wq).reshape(B, Sq, Hq, Dh), 0, 2, 1, 3)
        k = (lambda x, n, axis: torch.repeat_interleave(x, n, dim=axis))(k_cache[:, :, Sk - W:, :], rep, axis=1)
        v = (lambda x, n, axis: torch.repeat_interleave(x, n, dim=axis))(v_cache[:, :, Sk - W:, :], rep, axis=1)
        scores = torch.einsum("bhqd,bhkd->bhqk", q, k) * (Dh ** -0.5)
        p = _softmax(scores, axis=-1)
        o = torch.einsum("bhqk,bhkd->bhqd", p, v)
        return (lambda x, *d: x.permute(*d))(o, 0, 2, 1, 3).reshape(B, Sq, Hq * Dh) @ wo

    def _B_ref(x, w_gate, w_up, w_down):
        g = torch.einsum("bsd,df->bsf", x, w_gate)
        u = torch.einsum("bsd,df->bsf", x, w_up)
        h = _gelu(g) * u
        return torch.einsum("bsf,fd->bsd", h, w_down)

    x = A_x
    xn = _layernorm(x, axis=-1)
    return x + _A_ref(xn, A_k_cache, A_v_cache, A_wq, A_wo) + _B_ref(xn, B_w_gate, B_w_up, B_w_down)
```

```asm
; @launch grid=(256,1,1) block=(768,1,1) lds=6144
.amdgcn_target "amdgcn-amd-amdhsa--gfx950"
.text
.p2align 12
.fill 832, 4, 0xbf810000
.globl parallel_sum__sliding_block_cached__glu_gated_geglu__decode_kernel
.p2align 8
.type parallel_sum__sliding_block_cached__glu_gated_geglu__decode_kernel,@function
parallel_sum__sliding_block_cached__glu_gated_geglu__decode_kernel:
    s_load_dwordx16 s[16:31], s[0:1], 0
    s_load_dwordx8 s[32:39], s[0:1], 64
    v_lshrrev_b32 v1, 6, v0
    s_cmp_ge_u32 s2, 256
    s_cbranch_scc1 L_end
    v_readfirstlane_b32 s3, v1
    v_and_b32 v0, 63, v0
    s_and_b32 s4, s2, 7
    s_lshr_b32 s5, s2, 3
    s_and_b32 s8, s3, 3
    s_cmp_ge_u32 s3, 2
    s_cbranch_scc1 L_KV
    s_setprio 3
    v_and_b32 v3, 7, v0
    v_lshlrev_b32 v3, 4, v3
    s_cmp_eq_u32 s3, 1
    s_cbranch_scc1 L_A1pre
    s_lshr_b32 s61, s5, 3
    s_mul_i32 s14, s61, 112
    v_lshrrev_b32 v2, 3, v0
    v_mul_u32_u24 v2, 14, v2
    v_add_u32 v2, s14, v2
    v_lshl_add_u32 v2, v2, 13, v3
    s_and_b32 s62, s5, 7
    s_lshl3_add_u32 s60, s4, s62
    s_movk_i32 s62, 8192
    v_and_b32 v4, 1, v0
    v_lshrrev_b32 v5, 4, v0
    v_lshl_add_u32 v4, v5, 1, v4
    s_branch L_S1
L_A1z:
    s_cmp_lg_u32 s5, 0
    s_cbranch_scc1 L_end
    v_lshlrev_b32 v1, 4, v0
    v_mov_b32 v4, 0
    v_mov_b32 v5, 0
    v_mov_b32 v6, 0
    v_mov_b32 v7, 0
    s_movk_i32 s14, 16384
    s_waitcnt lgkmcnt(0)
    s_mov_b32 s40, s38
    s_mov_b32 s41, s39
    s_mov_b32 s42, 2097152
    s_mov_b32 s43, 0x20000
L_zl:
    buffer_store_dwordx4 v[4:7], v1, s[40:43], s14 offen sc1
    s_addk_i32 s14, 1024
    s_cmpk_lt_u32 s14, 30720
    s_cbranch_scc1 L_zl
    s_barrier
    s_branch L_ZERO
L_A1pre:
    s_cmp_eq_u32 s4, 7
    s_cbranch_scc1 L_A1z
    s_lshr_b32 s61, s5, 2
    s_mul_i32 s14, s61, 56
    s_movk_i32 s62, 3584
    v_lshrrev_b32 v4, 4, v0
    v_mul_u32_u24 v2, 14, v4
    v_add_u32 v2, s14, v2
    v_mad_u32_u24 v2, v2, s62, v3
    s_and_b32 s60, s5, 3
    s_xor_b32 s60, s60, 2
    s_lshl2_add_u32 s60, s4, s60
L_S1:
    s_lshl_b32 s63, s60, 7
    v_add_u32 v2, s63, v2
    v_mov_b32 v3, 0
    s_mov_b32 s63, 0
    v_mul_u32_u24 v4, 28, v4
    s_lshl_b32 s14, s14, 1
    v_add_u32 v4, s14, v4
    v_bfe_u32 v5, v0, 1, 1
    v_mul_u32_u24 v5, 896, v5
    v_add_u32 v4, v4, v5
    v_lshrrev_b32 v6, 2, v0
    v_and_b32 v7, 1, v0
    v_lshl_add_u32 v6, v6, 1, v7
    v_lshl_add_u32 v5, v6, 5, v5
    v_cmp_gt_u32 vcc, 56, v0
    v_mov_b32 v7, 0x10000
    s_nop 0
    v_cndmask_b32 v5, v7, v5, vcc
    s_movk_i32 s46, 1792
    s_mov_b32 s47, 0x20000
    s_cmp_eq_u32 s3, 1
    s_waitcnt lgkmcnt(0)
    s_mov_b64 s[44:45], s[16:17]
    s_cselect_b64 s[52:53], s[28:29], s[22:23]
    s_cselect_b64 s[54:55], s[30:31], s[22:23]
    v_lshl_add_u64 v[6:7], v[2:3], 0, s[54:55]
    v_lshl_add_u64 v[2:3], v[2:3], 0, s[52:53]
    buffer_load_dwordx4 v[8:11], v5, s[44:47], 0 offen
    buffer_load_dwordx4 v[12:15], v5, s[44:47], 0 offen offset:16
    buffer_load_dwordx4 v[16:19], v4, s[44:47], 0 offen
    buffer_load_dwordx3 v[20:22], v4, s[44:47], 0 offen offset:16
    v_mov_b32_dpp v2, v6 quad_perm:[0,1,2,3] row_mask:0xf bank_mask:0xc
    v_mov_b32_dpp v3, v7 quad_perm:[0,1,2,3] row_mask:0xf bank_mask:0xc
    global_load_dwordx4 v[32:35], v[2:3], off nt
    v_lshl_add_u64 v[2:3], v[2:3], 0, s[62:63]
    global_load_dwordx4 v[36:39], v[2:3], off nt
    v_lshl_add_u64 v[2:3], v[2:3], 0, s[62:63]
    global_load_dwordx4 v[40:43], v[2:3], off nt
    v_lshl_add_u64 v[2:3], v[2:3], 0, s[62:63]
    global_load_dwordx4 v[44:47], v[2:3], off nt
    v_lshl_add_u64 v[2:3], v[2:3], 0, s[62:63]
    global_load_dwordx4 v[48:51], v[2:3], off nt
    v_lshl_add_u64 v[2:3], v[2:3], 0, s[62:63]
    global_load_dwordx4 v[52:55], v[2:3], off nt
    v_lshl_add_u64 v[2:3], v[2:3], 0, s[62:63]
    global_load_dwordx4 v[56:59], v[2:3], off nt
    v_lshl_add_u64 v[2:3], v[2:3], 0, s[62:63]
    global_load_dwordx4 v[60:63], v[2:3], off nt
    v_lshl_add_u64 v[2:3], v[2:3], 0, s[62:63]
    global_load_dwordx4 v[64:67], v[2:3], off nt
    v_lshl_add_u64 v[2:3], v[2:3], 0, s[62:63]
    global_load_dwordx4 v[68:71], v[2:3], off nt
    v_lshl_add_u64 v[2:3], v[2:3], 0, s[62:63]
    global_load_dwordx4 v[72:75], v[2:3], off nt
    v_lshl_add_u64 v[2:3], v[2:3], 0, s[62:63]
    global_load_dwordx4 v[76:79], v[2:3], off nt
    v_lshl_add_u64 v[2:3], v[2:3], 0, s[62:63]
    global_load_dwordx4 v[80:83], v[2:3], off nt
    v_lshl_add_u64 v[2:3], v[2:3], 0, s[62:63]
    global_load_dwordx4 v[84:87], v[2:3], off nt
    s_barrier
    s_branch L_S2
L_KV:
    s_cmp_lt_u32 s3, 4
    s_cbranch_scc1 L_A23
    s_lshr_b32 s6, s5, 4
    s_lshl3_add_u32 s60, s6, s4
    s_lshl_b32 s60, s60, 7
    s_and_b32 s14, s5, 15
    s_add_u32 s60, s60, s14
    s_add_u32 s60, s60, 112
    s_lshl_b32 s60, s60, 17
    s_lshl_b32 s9, s4, 2
    s_xor_b32 s9, s9, s5
    s_cmp_lt_u32 s3, 8
    s_cbranch_scc1 L_K
    s_barrier
    s_branch L_V
L_A23:
    s_getpc_b64 s[60:61]
L_pc:
    s_sub_u32 s60, s60, L_pc-parallel_sum__sliding_block_cached__glu_gated_geglu__decode_kernel
    s_subb_u32 s61, s61, 0
    s_and_b32 s14, s3, 1
    s_lshl_b32 s14, s14, 13
    v_lshlrev_b32 v1, 7, v0
    v_add_u32 v1, s14, v1
    v_min_u32 v1, L_end-parallel_sum__sliding_block_cached__glu_gated_geglu__decode_kernel, v1
    global_load_dword v8, v1, s[60:61]
    s_cmp_eq_u32 s3, 2
    s_cbranch_scc1 L_A2
    v_lshlrev_b32 v1, 4, v0
    v_mov_b32 v2, 0
    v_mov_b32 v3, 0
    v_mov_b32 v4, 0
    v_mov_b32 v5, 0
    ds_write_b128 v1, v[2:5]
    v_mov_b32 v6, 0xff800000
    v_mov_b32 v7, v6
    ds_write_b64 v2, v[6:7] offset:16
    s_waitcnt lgkmcnt(0)
    s_barrier
    s_branch L_A3
L_A2:
    s_barrier
    s_mov_b64 exec, 0
    s_branch L_pad9
L_K:
    s_setprio 2
    v_and_b32 v2, 3, v0
    v_lshlrev_b32 v1, 9, v2
    v_lshrrev_b32 v2, 2, v0
    v_lshl_add_u32 v1, v2, 4, v1
    s_lshl_b32 s14, s8, 15
    v_add_u32 v1, s14, v1
    s_lshr_b32 s61, s9, 1
    s_lshl_b32 s14, s8, 2
    s_xor_b32 s61, s61, s14
    s_lshl_b32 s62, s61, 11
    s_mov_b32 s46, 0x20000
    s_mov_b32 s47, 0x20000
    s_waitcnt lgkmcnt(0)
    s_add_u32 s44, s18, s60
    s_addc_u32 s45, s19, 0
    s_barrier
    buffer_load_dwordx4 v[32:35], v1, s[44:47], s62 offen nt
    buffer_load_dwordx4 v[36:39], v1, s[44:47], s62 offen offset:256 nt
    s_xor_b32 s14, s62, 2048
    buffer_load_dwordx4 v[40:43], v1, s[44:47], s14 offen nt
    buffer_load_dwordx4 v[44:47], v1, s[44:47], s14 offen offset:256 nt
    s_xor_b32 s14, s62, 4096
    buffer_load_dwordx4 v[48:51], v1, s[44:47], s14 offen nt
    buffer_load_dwordx4 v[52:55], v1, s[44:47], s14 offen offset:256 nt
    s_xor_b32 s14, s62, 6144
    buffer_load_dwordx4 v[56:59], v1, s[44:47], s14 offen nt
    buffer_load_dwordx4 v[60:63], v1, s[44:47], s14 offen offset:256 nt
    s_xor_b32 s14, s62, 8192
    buffer_load_dwordx4 v[64:67], v1, s[44:47], s14 offen nt
    buffer_load_dwordx4 v[68:71], v1, s[44:47], s14 offen offset:256 nt
    s_xor_b32 s14, s62, 10240
    buffer_load_dwordx4 v[72:75], v1, s[44:47], s14 offen nt
    buffer_load_dwordx4 v[76:79], v1, s[44:47], s14 offen offset:256 nt
    s_mov_b32 s40, s38
    s_mov_b32 s41, s39
    s_mov_b32 s42, 2097152
    s_mov_b32 s43, 0x20000
    s_load_dword s13, s[40:41], 0
    s_mov_b32 s15, 131072
    s_mov_b32 s56, 0x05040100
    s_mov_b32 s57, 0x07060302
    s_mov_b32 s58, 0xffffff00
    s_mov_b32 s59, 1035512379
    v_and_b32 v3, 31, v0
    v_lshlrev_b32 v3, 4, v3
    v_lshrrev_b32 v2, 5, v0
    v_lshl_add_u32 v3, v2, 11, v3
    s_lshl_b32 s52, s4, 14
    s_lshl_b32 s14, s6, 13
    s_add_u32 s52, s52, s14
    s_lshl_b32 s14, s8, 9
    s_add_u32 s52, s52, s14
    s_add_u32 s52, s52, 65536
    s_add_u32 s53, s52, 4096
    v_mov_b32 v5, 0
    v_mov_b32 v167, 1
    s_xor_b32 s14, s62, 12288
    buffer_load_dwordx4 v[80:83], v1, s[44:47], s14 offen nt
    buffer_load_dwordx4 v[84:87], v1, s[44:47], s14 offen offset:256 nt
    s_xor_b32 s14, s62, 14336
    buffer_load_dwordx4 v[88:91], v1, s[44:47], s14 offen nt
    buffer_load_dwordx4 v[92:95], v1, s[44:47], s14 offen offset:256 nt
    s_xor_b32 s14, s62, 16384
    buffer_load_dwordx4 v[96:99], v1, s[44:47], s14 offen nt
    buffer_load_dwordx4 v[100:103], v1, s[44:47], s14 offen offset:256 nt
    s_xor_b32 s14, s62, 18432
    buffer_load_dwordx4 v[104:107], v1, s[44:47], s14 offen nt
    buffer_load_dwordx4 v[108:111], v1, s[44:47], s14 offen offset:256 nt
    s_mov_b64 exec, 1
    ds_add_u32 v5, v167 offset:40
    s_mov_b64 exec, -1
    s_xor_b32 s14, s62, 20480
    buffer_load_dwordx4 v[112:115], v1, s[44:47], s14 offen nt
    buffer_load_dwordx4 v[116:119], v1, s[44:47], s14 offen offset:256 nt
    s_xor_b32 s14, s62, 22528
    buffer_load_dwordx4 v[120:123], v1, s[44:47], s14 offen nt
    buffer_load_dwordx4 v[124:127], v1, s[44:47], s14 offen offset:256 nt
    buffer_load_dwordx4 v[16:19], v3, s[40:43], s52 offen sc1 nt
    buffer_load_dwordx4 v[20:23], v3, s[40:43], s53 offen sc1 nt
    s_xor_b32 s14, s62, 24576
    buffer_load_dwordx4 v[128:131], v1, s[44:47], s14 offen nt
    buffer_load_dwordx4 v[132:135], v1, s[44:47], s14 offen offset:256 nt
    s_xor_b32 s14, s62, 26624
    buffer_load_dwordx4 v[136:139], v1, s[44:47], s14 offen nt
    buffer_load_dwordx4 v[140:143], v1, s[44:47], s14 offen offset:256 nt
    s_xor_b32 s14, s62, 28672
    buffer_load_dwordx4 v[144:147], v1, s[44:47], s14 offen nt
    buffer_load_dwordx4 v[148:151], v1, s[44:47], s14 offen offset:256 nt
    s_xor_b32 s14, s62, 30720
    buffer_load_dwordx4 v[152:155], v1, s[44:47], s14 offen nt
    buffer_load_dwordx4 v[156:159], v1, s[44:47], s14 offen offset:256 nt
    v_and_b32 v2, 1, v0
    v_lshlrev_b32 v2, 9, v2
    v_lshrrev_b32 v6, 2, v0
    v_lshl_add_u32 v2, v6, 4, v2
    s_lshl_b32 s14, s61, 2
    s_lshl_b32 s62, s8, 6
    s_or_b32 s14, s14, s62
    s_lshr_b32 s62, s9, 3
    s_lshl_b32 s62, s62, 6
    s_xor_b32 s14, s14, s62
    s_and_b32 s62, s9, 7
    s_xor_b32 s14, s14, s62
    v_xor_b32 v4, s14, v0
    v_lshlrev_b32 v4, 1, v4
    v_and_b32 v1, 7, v0
    v_lshlrev_b32 v1, 4, v1
    v_and_b32 v9, 8, v0
    v_or_b32 v1, v1, v9
    v_bfe_u32 v9, v0, 4, 1
    v_lshl_add_u32 v1, v9, 7, v1
    v_lshrrev_b32 v9, 5, v0
    v_lshl_add_u32 v1, v9, 2, v1
    s_lshl_b32 s14, s8, 8
    v_add_u32 v1, s14, v1
    s_waitcnt lgkmcnt(0)
    s_add_u32 s12, s13, 1
    s_mul_i32 s92, s12, 0x01030507
    s_bfe_u32 s88, s92, 524288
    s_bfe_u32 s89, s92, 524296
    s_bfe_u32 s90, s92, 524304
    s_bfe_u32 s91, s92, 524312
    s_lshr_b32 s93, s92, 8
    s_and_b32 s94, s92, 0xffff
    s_lshr_b32 s95, s92, 16
L_pad1:
    s_cbranch_execz L_pad2
    s_waitcnt vmcnt(8)
L_cq:
    v_xor_b32 v16, s88, v16
    v_xor_b32 v17, s89, v17
    v_xor_b32 v18, s90, v18
    v_xor_b32 v19, s91, v19
    v_xor_b32 v20, s88, v20
    v_xor_b32 v21, s89, v21
    v_xor_b32 v22, s90, v22
    v_xor_b32 v23, s91, v23
    v_or_b32 v8, v16, v17
    v_or3_b32 v8, v8, v18, v19
    v_or3_b32 v8, v8, v20, v21
    v_or3_b32 v8, v8, v22, v23
    v_and_b32 v8, 0xff, v8
    v_cmp_ne_u32 vcc, 0, v8
    s_cbranch_vccnz L_rq
    v_add_f32 v16, v16, v20
    v_add_f32 v17, v17, v21
    v_add_f32 v18, v18, v22
    v_add_f32 v19, v19, v23
    s_nop 0
    v_permlane32_swap_b32 v16, v18
    v_permlane32_swap_b32 v17, v19
    v_add_f32 v16, v16, v18
    v_add_f32 v17, v17, v19
    v_cvt_pk_bf16_f32 v16, v16, v17
    ds_write_b32 v1, v16 offset:1024
    s_mov_b64 exec, 1
    ds_add_u32 v5, v167 offset:0
    s_mov_b64 exec, -1
L_sp1:
    ds_read_b32 v6, v5 offset:0
    s_waitcnt lgkmcnt(0)
    v_readfirstlane_b32 s14, v6
    s_cmp_ge_u32 s14, 4
    s_cbranch_scc1 L_sd2
    s_sleep 1
    s_sub_u32 s15, s15, 1
    s_cbranch_scc0 L_sp1
    s_endpgm
L_sd2:
    ds_read_b128 v[8:11], v2 offset:1024
    ds_read_b128 v[12:15], v2 offset:1280
    s_waitcnt lgkmcnt(0)
    v_mfma_f32_4x4x4_16b_bf16 v[16:19], v[8:9], v[32:33], 0
    v_mfma_f32_4x4x4_16b_bf16 v[20:23], v[8:9], v[40:41], 0
    v_mfma_f32_4x4x4_16b_bf16 v[24:27], v[8:9], v[48:49], 0
    v_mfma_f32_4x4x4_16b_bf16 v[28:31], v[8:9], v[56:57], 0
    v_mfma_f32_4x4x4_16b_bf16 v[16:19], v[10:11], v[34:35], v[16:19]
    v_mfma_f32_4x4x4_16b_bf16 v[20:23], v[10:11], v[42:43], v[20:23]
    v_mfma_f32_4x4x4_16b_bf16 v[24:27], v[10:11], v[50:51], v[24:27]
    v_mfma_f32_4x4x4_16b_bf16 v[28:31], v[10:11], v[58:59], v[28:31]
    v_mfma_f32_4x4x4_16b_bf16 v[16:19], v[12:13], v[36:37], v[16:19]
    v_mfma_f32_4x4x4_16b_bf16 v[20:23], v[12:13], v[44:45], v[20:23]
    v_mfma_f32_4x4x4_16b_bf16 v[24:27], v[12:13], v[52:53], v[24:27]
    v_mfma_f32_4x4x4_16b_bf16 v[28:31], v[12:13], v[60:61], v[28:31]
    v_mfma_f32_4x4x4_16b_bf16 v[16:19], v[14:15], v[38:39], v[16:19]
    v_mfma_f32_4x4x4_16b_bf16 v[20:23], v[14:15], v[46:47], v[20:23]
    v_mfma_f32_4x4x4_16b_bf16 v[24:27], v[14:15], v[54:55], v[24:27]
    v_mfma_f32_4x4x4_16b_bf16 v[28:31], v[14:15], v[62:63], v[28:31]
    v_mfma_f32_4x4x4_16b_bf16 v[32:35], v[8:9], v[64:65], 0
    v_mfma_f32_4x4x4_16b_bf16 v[36:39], v[8:9], v[72:73], 0
    v_mfma_f32_4x4x4_16b_bf16 v[40:43], v[8:9], v[80:81], 0
    v_mfma_f32_4x4x4_16b_bf16 v[44:47], v[8:9], v[88:89], 0
    v_mfma_f32_4x4x4_16b_bf16 v[32:35], v[10:11], v[66:67], v[32:35]
    v_mfma_f32_4x4x4_16b_bf16 v[36:39], v[10:11], v[74:75], v[36:39]
    v_mfma_f32_4x4x4_16b_bf16 v[40:43], v[10:11], v[82:83], v[40:43]
    v_mfma_f32_4x4x4_16b_bf16 v[44:47], v[10:11], v[90:91], v[44:47]
    v_mfma_f32_4x4x4_16b_bf16 v[32:35], v[12:13], v[68:69], v[32:35]
    v_mfma_f32_4x4x4_16b_bf16 v[36:39], v[12:13], v[76:77], v[36:39]
    v_mfma_f32_4x4x4_16b_bf16 v[40:43], v[12:13], v[84:85], v[40:43]
    v_mfma_f32_4x4x4_16b_bf16 v[44:47], v[12:13], v[92:93], v[44:47]
    v_mfma_f32_4x4x4_16b_bf16 v[32:35], v[14:15], v[70:71], v[32:35]
    v_mfma_f32_4x4x4_16b_bf16 v[36:39], v[14:15], v[78:79], v[36:39]
    v_mfma_f32_4x4x4_16b_bf16 v[40:43], v[14:15], v[86:87], v[40:43]
    v_mfma_f32_4x4x4_16b_bf16 v[44:47], v[14:15], v[94:95], v[44:47]
    v_mfma_f32_4x4x4_16b_bf16 v[64:67], v[8:9], v[96:97], 0
    v_mfma_f32_4x4x4_16b_bf16 v[68:71], v[8:9], v[104:105], 0
    v_mfma_f32_4x4x4_16b_bf16 v[72:75], v[8:9], v[112:113], 0
    v_mfma_f32_4x4x4_16b_bf16 v[76:79], v[8:9], v[120:121], 0
    v_mfma_f32_4x4x4_16b_bf16 v[64:67], v[10:11], v[98:99], v[64:67]
    v_mfma_f32_4x4x4_16b_bf16 v[68:71], v[10:11], v[106:107], v[68:71]
    v_mfma_f32_4x4x4_16b_bf16 v[72:75], v[10:11], v[114:115], v[72:75]
    v_mfma_f32_4x4x4_16b_bf16 v[76:79], v[10:11], v[122:123], v[76:79]
    v_mfma_f32_4x4x4_16b_bf16 v[64:67], v[12:13], v[100:101], v[64:67]
    v_mfma_f32_4x4x4_16b_bf16 v[68:71], v[12:13], v[108:109], v[68:71]
    v_mfma_f32_4x4x4_16b_bf16 v[72:75], v[12:13], v[116:117], v[72:75]
    v_mfma_f32_4x4x4_16b_bf16 v[76:79], v[12:13], v[124:125], v[76:79]
    v_mfma_f32_4x4x4_16b_bf16 v[64:67], v[14:15], v[102:103], v[64:67]
    v_mfma_f32_4x4x4_16b_bf16 v[68:71], v[14:15], v[110:111], v[68:71]
    v_mfma_f32_4x4x4_16b_bf16 v[72:75], v[14:15], v[118:119], v[72:75]
    v_mfma_f32_4x4x4_16b_bf16 v[76:79], v[14:15], v[126:127], v[76:79]
    s_waitcnt vmcnt(0)
    v_mfma_f32_4x4x4_16b_bf16 v[96:99], v[8:9], v[128:129], 0
    v_mfma_f32_4x4x4_16b_bf16 v[100:103], v[8:9], v[136:137], 0
    v_mfma_f32_4x4x4_16b_bf16 v[104:107], v[8:9], v[144:145], 0
    v_mfma_f32_4x4x4_16b_bf16 v[108:111], v[8:9], v[152:153], 0
    v_mfma_f32_4x4x4_16b_bf16 v[96:99], v[10:11], v[130:131], v[96:99]
    v_mfma_f32_4x4x4_16b_bf16 v[100:103], v[10:11], v[138:139], v[100:103]
    v_mfma_f32_4x4x4_16b_bf16 v[104:107], v[10:11], v[146:147], v[104:107]
    v_mfma_f32_4x4x4_16b_bf16 v[108:111], v[10:11], v[154:155], v[108:111]
    v_mfma_f32_4x4x4_16b_bf16 v[96:99], v[12:13], v[132:133], v[96:99]
    v_mfma_f32_4x4x4_16b_bf16 v[100:103], v[12:13], v[140:141], v[100:103]
    v_mfma_f32_4x4x4_16b_bf16 v[104:107], v[12:13], v[148:149], v[104:107]
    v_mfma_f32_4x4x4_16b_bf16 v[108:111], v[12:13], v[156:157], v[108:111]
    v_mfma_f32_4x4x4_16b_bf16 v[96:99], v[14:15], v[134:135], v[96:99]
    v_mfma_f32_4x4x4_16b_bf16 v[100:103], v[14:15], v[142:143], v[100:103]
    v_mfma_f32_4x4x4_16b_bf16 v[104:107], v[14:15], v[150:151], v[104:107]
    v_mfma_f32_4x4x4_16b_bf16 v[108:111], v[14:15], v[158:159], v[108:111]
L_pad2:
    s_cbranch_execz L_pad3
    v_permlane32_swap_b32 v16, v64
    v_permlane32_swap_b32 v17, v65
    v_permlane32_swap_b32 v20, v68
    v_permlane32_swap_b32 v21, v69
    v_permlane32_swap_b32 v24, v72
    v_permlane32_swap_b32 v25, v73
    v_permlane32_swap_b32 v28, v76
    v_permlane32_swap_b32 v29, v77
    v_permlane32_swap_b32 v32, v96
    v_permlane32_swap_b32 v33, v97
    v_permlane32_swap_b32 v36, v100
    v_permlane32_swap_b32 v37, v101
    v_permlane32_swap_b32 v40, v104
    v_permlane32_swap_b32 v41, v105
    v_permlane32_swap_b32 v44, v108
    v_permlane32_swap_b32 v45, v109
    v_add_f32 v16, v16, v64
    v_add_f32 v17, v17, v65
    v_add_f32 v20, v20, v68
    v_add_f32 v21, v21, v69
    v_add_f32 v24, v24, v72
    v_add_f32 v25, v25, v73
    v_add_f32 v28, v28, v76
    v_add_f32 v29, v29, v77
    v_add_f32 v32, v32, v96
    v_add_f32 v33, v33, v97
    v_add_f32 v36, v36, v100
    v_add_f32 v37, v37, v101
    v_add_f32 v40, v40, v104
    v_add_f32 v41, v41, v105
    v_add_f32 v44, v44, v108
    v_add_f32 v45, v45, v109
    v_permlane16_swap_b32 v16, v32
    v_permlane16_swap_b32 v17, v33
    v_permlane16_swap_b32 v20, v36
    v_permlane16_swap_b32 v21, v37
    v_permlane16_swap_b32 v24, v40
    v_permlane16_swap_b32 v25, v41
    v_permlane16_swap_b32 v28, v44
    v_permlane16_swap_b32 v29, v45
    v_add_f32 v16, v16, v32
    v_add_f32 v17, v17, v33
    v_add_f32 v20, v20, v36
    v_add_f32 v21, v21, v37
    v_add_f32 v24, v24, v40
    v_add_f32 v25, v25, v41
    v_add_f32 v28, v28, v44
    v_add_f32 v29, v29, v45
    v_add_f32_dpp v160, v16, v16 row_ror:8 row_mask:0xf bank_mask:0x3
    v_add_f32_dpp v161, v17, v17 row_ror:8 row_mask:0xf bank_mask:0x3
    v_add_f32_dpp v162, v20, v20 row_ror:8 row_mask:0xf bank_mask:0x3
    v_add_f32_dpp v163, v21, v21 row_ror:8 row_mask:0xf bank_mask:0x3
    v_add_f32_dpp v160, v24, v24 row_ror:8 row_mask:0xf bank_mask:0xc
    v_add_f32_dpp v161, v25, v25 row_ror:8 row_mask:0xf bank_mask:0xc
    v_add_f32_dpp v162, v28, v28 row_ror:8 row_mask:0xf bank_mask:0xc
    v_add_f32_dpp v163, v29, v29 row_ror:8 row_mask:0xf bank_mask:0xc
    v_add_f32_dpp v164, v160, v160 row_shl:4 row_mask:0xf bank_mask:0x5
    v_add_f32_dpp v165, v161, v161 row_shl:4 row_mask:0xf bank_mask:0x5
    s_nop 0
    v_add_f32_dpp v164, v162, v162 row_shr:4 row_mask:0xf bank_mask:0xa
    v_add_f32_dpp v165, v163, v163 row_shr:4 row_mask:0xf bank_mask:0xa
    v_cvt_pk_bf16_f32 v166, v164, v165
    v_lshlrev_b32 v164, 16, v166
    v_and_b32 v165, 0xffff0000, v166
    v_mov_b32 v16, v164
    v_mov_b32 v17, v165
    s_nop 1
    v_permlane32_swap_b32 v16, v17
    v_max_f32 v16, v16, v17
    v_mov_b32 v17, v16
    s_nop 1
    v_permlane16_swap_b32 v17, v16
    v_max_f32 v16, v17, v16
    s_nop 1
    v_max_f32_dpp v16, v16, v16 row_ror:8 row_mask:0xf bank_mask:0xf
    s_nop 1
    v_max_f32_dpp v16, v16, v16 row_ror:4 row_mask:0xf bank_mask:0xf
    s_nop 1
    v_max_f32_dpp v16, v16, v16 row_ror:2 row_mask:0xf bank_mask:0xf
    s_nop 1
    v_max_f32_dpp v16, v16, v16 row_ror:1 row_mask:0xf bank_mask:0xf
    v_lshrrev_b32 v18, 5, v0
    v_lshlrev_b32 v18, 2, v18
    s_mov_b32 exec_lo, 1
    s_mov_b32 exec_hi, 1
    ds_max_f32 v18, v16 offset:16
    s_mov_b32 exec_hi, 0
    ds_add_u32 v5, v167 offset:8
    s_mov_b64 exec, -1
L_sp3:
    ds_read_b32 v6, v5 offset:8
    s_waitcnt lgkmcnt(0)
    v_readfirstlane_b32 s14, v6
    s_cmp_ge_u32 s14, 4
    s_cbranch_scc1 L_sd4
    s_sleep 1
    s_sub_u32 s15, s15, 1
    s_cbranch_scc0 L_sp3
    s_endpgm
L_sd4:
    ds_read_b64 v[20:21], v5 offset:16
    s_waitcnt lgkmcnt(0)
    v_sub_f32 v22, v164, v20
    v_sub_f32 v23, v165, v21
    v_mul_f32 v22, s59, v22
    v_mul_f32 v23, s59, v23
    v_exp_f32 v22, v22
    v_exp_f32 v23, v23
    s_nop 0
    v_cvt_pk_bf16_f32 v24, v22, v23
    ds_write_b16 v4, v24 offset:2048
    ds_write_b16_d16_hi v4, v24 offset:2560
    s_mov_b64 exec, 1
    ds_add_u32 v5, v167 offset:4
    s_mov_b64 exec, -1
    s_cmp_ge_u32 s5, 28
    s_cbranch_scc1 L_Kx
L_pad3:
    s_cbranch_execz L_pad4
    v_lshrrev_b32 v2, 3, v0
    v_and_b32 v3, 7, v0
    v_lshlrev_b32 v3, 4, v3
    v_mul_u32_u24 v13, 7168, v2
    v_add_u32 v13, v13, v3
    v_mov_b32 v48, 0
    v_mov_b32 v49, 0
    v_mov_b32 v50, 0
    v_mov_b32 v51, 0
    v_mov_b32 v52, 0
    v_mov_b32 v53, 0
    v_mov_b32 v54, 0
    v_mov_b32 v55, 0
    v_mov_b32 v67, 0
    v_mov_b32 v71, 0
    v_mov_b32 v75, 0
    v_mov_b32 v79, 0
    v_mov_b32 v83, 0
    v_mov_b32 v87, 0
    v_mov_b32 v91, 0
    v_mov_b32 v95, 0
    v_mov_b32 v112, 0
    v_mov_b32 v113, 0
    v_mov_b32 v114, 0
    v_mov_b32 v115, 0
    v_mov_b32 v116, 0
    v_mov_b32 v117, 0
    v_mov_b32 v118, 0
    v_mov_b32 v119, 0
    v_mov_b32 v120, 0
    v_mov_b32 v121, 0
    v_mov_b32 v122, 0
    v_mov_b32 v123, 0
    v_mov_b32 v124, 0
    v_mov_b32 v125, 0
    v_mov_b32 v126, 0
    v_mov_b32 v127, 0
    v_and_b32 v2, 1, v0
    v_lshrrev_b32 v3, 4, v0
    v_lshl_add_u32 v2, v3, 1, v2
    v_bfe_u32 v3, v0, 1, 1
    v_bfe_u32 v6, v0, 2, 2
    v_lshlrev_b32 v1, 4, v0
    v_lshlrev_b32 v12, 4, v6
    v_lshl_add_u32 v12, v3, 6, v12
    v_lshlrev_b32 v4, 3, v2
    v_lshl_add_u32 v4, v3, 6, v4
    v_mov_b32 v28, s94
    v_mov_b32 v29, s95
    v_and_b32 v2, 15, v0
    v_lshlrev_b32 v2, 5, v2
    v_lshrrev_b32 v3, 4, v0
    v_lshl_add_u32 v2, v3, 3, v2
    s_lshl_b32 s14, s8, 9
    v_add_u32 v2, s14, v2
    s_mul_i32 s10, s5, 37
    s_lshr_b32 s10, s10, 8
    s_mul_i32 s11, s10, 7
    s_sub_u32 s11, s5, s11
    s_lshl_b32 s14, s10, 6
    s_and_b32 s14, s14, 128
    v_add_u32 v12, s14, v12
    s_lshl2_add_u32 s10, s4, s10
    s_lshl_b32 s62, s11, 7
    v_lshrrev_b32 v3, 1, v0
    v_lshlrev_b32 v15, 2, v3
    s_lshl_b32 s14, s8, 7
    v_add_u32 v15, s14, v15
    s_lshr_b32 s14, s8, 1
    s_mul_i32 s14, s14, 896
    s_add_u32 s14, s14, s62
    s_and_b32 s60, s8, 1
    s_lshl_b32 s60, s60, 6
    s_add_u32 s14, s14, s60
    v_lshl_add_u32 v14, v3, 1, s14
    v_lshlrev_b32 v30, 3, v0
    s_mov_b32 s44, s16
    s_mov_b32 s45, s17
    s_mov_b32 s46, 1792
    s_mov_b32 s47, 0x20000
    buffer_load_ushort v56, v14, s[44:47], 0 offen
    s_movk_i32 s14, 6144
    buffer_load_dword v57, v5, s[40:43], s14 offen sc1
    s_lshl2_add_u32 s60, s11, s8
    s_lshl_b32 s60, s60, 9
    s_add_u32 s60, s60, 16384
    s_mov_b32 s44, s24
    s_mov_b32 s45, s25
    s_mov_b32 s46, 3670016
    s_mov_b32 s47, 0x20000
    s_mov_b32 s48, s32
    s_mov_b32 s49, s33
    s_mov_b32 s50, 1605632
    s_mov_b32 s51, 0x20000
    s_lshr_b32 s14, s8, 1
    s_lshl1_add_u32 s52, s10, s14
    s_and_b32 s14, s8, 1
    s_lshl4_add_u32 s52, s52, s14
    s_mul_i32 s52, s52, 3584
    s_add_u32 s52, s52, s62
    s_lshl_b32 s53, s10, 5
    s_add_u32 s53, s53, s8
    s_mul_i32 s53, s53, 1792
    s_add_u32 s53, s53, s62
    s_lshl2_add_u32 s55, s10, s8
    s_lshl_b32 s61, s55, 12
    s_add_u32 s61, s61, 524288
    s_lshl_b32 s55, s55, 7
    s_add_u32 s55, s55, 425984
L_sp5:
    ds_read_b32 v6, v5 offset:44
    s_waitcnt lgkmcnt(0)
    v_readfirstlane_b32 s14, v6
    s_cmp_ge_u32 s14, 1
    s_cbranch_scc1 L_sd6
    s_sleep 2
    s_sub_u32 s15, s15, 1
    s_cbranch_scc0 L_sp5
    s_endpgm
L_sd6:
    ds_read_b32 v6, v5 offset:28
    s_waitcnt vmcnt(0) lgkmcnt(0)
    v_add_u32 v1, v1, v6
    v_add_u32 v4, v4, v6
    v_lshlrev_b32 v56, 16, v56
    v_cvt_f64_f32 v[58:59], v56
L_cz:
    v_cmp_ne_u32 vcc, s12, v57
    s_cbranch_vccnz L_rz
L_sp7:
    ds_read_b32 v6, v5 offset:36
    s_waitcnt lgkmcnt(0)
    v_readfirstlane_b32 s14, v6
    s_cmp_ge_u32 s14, 4
    s_cbranch_scc1 L_sd8
    s_sleep 1
    s_sub_u32 s15, s15, 1
    s_cbranch_scc0 L_sp7
    s_endpgm
L_sd8:
    s_cmp_eq_u32 s4, 7
    s_cbranch_scc1 L_noh
    buffer_load_dwordx2 v[28:29], v4, s[40:43], s55 offen sc1 nt
    buffer_load_dwordx4 v[48:51], v13, s[48:51], s53 offen offset:0 nt
    buffer_load_dwordx4 v[52:55], v13, s[48:51], s53 offen offset:896 nt
L_noh:
    buffer_load_dwordx4 v[32:35], v13, s[44:47], s52 offen offset:0 nt
    buffer_load_dwordx4 v[36:39], v13, s[44:47], s52 offen offset:896 nt
    buffer_load_dwordx4 v[40:43], v13, s[44:47], s52 offen offset:1792 nt
    buffer_load_dwordx4 v[44:47], v13, s[44:47], s52 offen offset:2688 nt
    s_mov_b32 s44, s34
    s_mov_b32 s45, s35
    s_mov_b32 s46, 1792
    s_mov_b32 s47, 0x20000
    s_mov_b32 s52, 0x55555555
    s_mov_b32 s53, 0x55555555
    s_mov_b32 s54, 0x403f0000
L_pad4:
    s_cbranch_execz L_pad5
    s_waitcnt vmcnt(6)
L_ch:
    v_xor_b32 v8, s94, v28
    v_bitop3_b32 v8, v8, v29, s95 bitop3:0xf6
    v_cmp_ne_u32_sdwa vcc, v8, v5 src0_sel:WORD_0 src1_sel:DWORD
    s_cbranch_vccnz L_rh
    v_perm_b32 v28, v29, v28, s57
    v_mov_b32_dpp v114, v28 quad_perm:[0,1,2,3] row_mask:0xf bank_mask:1
    v_mov_b32_dpp v118, v28 quad_perm:[0,1,2,3] row_mask:0xf bank_mask:2
    v_mov_b32_dpp v122, v28 quad_perm:[0,1,2,3] row_mask:0xf bank_mask:4
    v_mov_b32_dpp v126, v28 quad_perm:[0,1,2,3] row_mask:0xf bank_mask:8
L_sp9:
    ds_read_b32 v6, v5 offset:12
    s_waitcnt lgkmcnt(0)
    v_readfirstlane_b32 s14, v6
    s_cmp_ge_u32 s14, 1
    s_cbranch_scc1 L_sd10
    s_sleep 1
    s_sub_u32 s15, s15, 1
    s_cbranch_scc0 L_sp9
    s_endpgm
L_sd10:
    ds_read_b128 v[24:27], v12 offset:3072
    s_waitcnt vmcnt(3)
L_sp11:
    ds_read_b32 v6, v5 offset:32
    s_waitcnt lgkmcnt(0)
    v_readfirstlane_b32 s14, v6
    s_cmp_ge_u32 s14, 4
    s_cbranch_scc1 L_sd12
    s_sub_u32 s15, s15, 1
    s_cbranch_scc0 L_sp11
    s_endpgm
L_sd12:
    s_setprio 3
    buffer_load_dwordx4 v[96:99], v1, s[40:43], s61 offen offset:0 sc1 nt
    buffer_load_dwordx4 v[100:103], v1, s[40:43], s61 offen offset:1024 sc1 nt
    buffer_load_dwordx4 v[104:107], v1, s[40:43], s61 offen offset:2048 sc1 nt
    buffer_load_dwordx4 v[108:111], v1, s[40:43], s61 offen offset:3072 sc1 nt
    s_waitcnt vmcnt(4)
    v_perm_b32 v64, v36, v32, s56
    v_perm_b32 v65, v44, v40, s56
    v_perm_b32 v66, v52, v48, s56
    v_perm_b32 v68, v36, v32, s57
    v_perm_b32 v69, v44, v40, s57
    v_perm_b32 v70, v52, v48, s57
    v_perm_b32 v72, v37, v33, s56
    v_perm_b32 v73, v45, v41, s56
    v_perm_b32 v74, v53, v49, s56
    v_perm_b32 v76, v37, v33, s57
    v_perm_b32 v77, v45, v41, s57
    v_perm_b32 v78, v53, v49, s57
    v_perm_b32 v80, v38, v34, s56
    v_perm_b32 v81, v46, v42, s56
    v_perm_b32 v82, v54, v50, s56
    v_perm_b32 v84, v38, v34, s57
    v_perm_b32 v85, v46, v42, s57
    v_perm_b32 v86, v54, v50, s57
    v_perm_b32 v88, v39, v35, s56
    v_perm_b32 v89, v47, v43, s56
    v_perm_b32 v90, v55, v51, s56
    v_perm_b32 v92, v39, v35, s57
    v_perm_b32 v93, v47, v43, s57
    v_perm_b32 v94, v55, v51, s57
L_pad5:
    s_cbranch_execz L_pad6
L_ck:
    s_waitcnt vmcnt(0)
    v_xor_b32 v132, s88, v96
    v_xor_b32 v136, s88, v100
    v_xor_b32 v140, s88, v104
    v_xor_b32 v144, s88, v108
    v_or3_b32 v8, v132, v136, v140
    v_or_b32 v8, v8, v144
    v_cmp_ne_u32_sdwa vcc, v8, v5 src0_sel:BYTE_0 src1_sel:DWORD
    v_xor_b32 v133, s89, v97
    v_xor_b32 v134, s90, v98
    v_xor_b32 v135, s91, v99
    s_cbranch_vccnz L_ra
    v_pk_mul_f32 v[128:129], v[132:133], v[24:25] op_sel_hi:[1,0]
    v_pk_mul_f32 v[130:131], v[134:135], v[24:25] op_sel_hi:[1,0]
    v_xor_b32 v137, s89, v101
    v_xor_b32 v138, s90, v102
    v_xor_b32 v139, s91, v103
    v_pk_fma_f32 v[128:129], v[136:137], v[24:25], v[128:129] op_sel:[0,1,0] op_sel_hi:[1,1,1]
    v_pk_fma_f32 v[130:131], v[138:139], v[24:25], v[130:131] op_sel:[0,1,0] op_sel_hi:[1,1,1]
    v_xor_b32 v141, s89, v105
    v_xor_b32 v142, s90, v106
    v_xor_b32 v143, s91, v107
    v_pk_fma_f32 v[128:129], v[140:141], v[26:27], v[128:129] op_sel_hi:[1,0,1]
    v_pk_fma_f32 v[130:131], v[142:143], v[26:27], v[130:131] op_sel_hi:[1,0,1]
    v_xor_b32 v145, s89, v109
    v_xor_b32 v146, s90, v110
    v_xor_b32 v147, s91, v111
    v_pk_fma_f32 v[128:129], v[144:145], v[26:27], v[128:129] op_sel:[0,1,0] op_sel_hi:[1,1,1]
    v_pk_fma_f32 v[130:131], v[146:147], v[26:27], v[130:131] op_sel:[0,1,0] op_sel_hi:[1,1,1]
    v_or_b32 v10, v133, v134
    v_add_f32_dpp v128, v128, v128 row_ror:4 row_mask:0xf bank_mask:0xf
    v_add_f32_dpp v129, v129, v129 row_ror:4 row_mask:0xf bank_mask:0xf
    v_add_f32_dpp v130, v130, v130 row_ror:4 row_mask:0xf bank_mask:0xf
    v_add_f32_dpp v131, v131, v131 row_ror:4 row_mask:0xf bank_mask:0xf
    v_add_f32_dpp v128, v128, v128 row_ror:8 row_mask:0xf bank_mask:0xf
    v_add_f32_dpp v129, v129, v129 row_ror:8 row_mask:0xf bank_mask:0xf
    v_add_f32_dpp v130, v130, v130 row_ror:8 row_mask:0xf bank_mask:0xf
    v_add_f32_dpp v131, v131, v131 row_ror:8 row_mask:0xf bank_mask:0xf
    v_cvt_pk_bf16_f32 v8, v128, v129
    v_cvt_pk_bf16_f32 v9, v130, v131
    v_or3_b32 v10, v10, v135, v137
    v_mov_b32_dpp v112, v8 quad_perm:[0,1,2,3] row_mask:0xf bank_mask:1
    v_mov_b32_dpp v113, v9 quad_perm:[0,1,2,3] row_mask:0xf bank_mask:1
    v_mov_b32_dpp v116, v8 quad_perm:[0,1,2,3] row_mask:0xf bank_mask:2
    v_mov_b32_dpp v117, v9 quad_perm:[0,1,2,3] row_mask:0xf bank_mask:2
    v_mfma_f32_16x16x32_bf16 v[16:19], v[112:115], v[64:67], 0
    v_mfma_f32_16x16x32_bf16 v[20:23], v[112:115], v[68:71], 0
    v_mov_b32_dpp v120, v8 quad_perm:[0,1,2,3] row_mask:0xf bank_mask:4
    v_mov_b32_dpp v121, v9 quad_perm:[0,1,2,3] row_mask:0xf bank_mask:4
    v_mfma_f32_16x16x32_bf16 v[16:19], v[116:119], v[72:75], v[16:19]
    v_mfma_f32_16x16x32_bf16 v[20:23], v[116:119], v[76:79], v[20:23]
    v_mov_b32_dpp v124, v8 quad_perm:[0,1,2,3] row_mask:0xf bank_mask:8
    v_mov_b32_dpp v125, v9 quad_perm:[0,1,2,3] row_mask:0xf bank_mask:8
    v_mfma_f32_16x16x32_bf16 v[16:19], v[120:123], v[80:83], v[16:19]
    v_mfma_f32_16x16x32_bf16 v[20:23], v[120:123], v[84:87], v[20:23]
    v_mfma_f32_16x16x32_bf16 v[16:19], v[124:127], v[88:91], v[16:19]
    v_or3_b32 v10, v10, v138, v139
    v_mfma_f32_16x16x32_bf16 v[20:23], v[124:127], v[92:95], v[20:23]
    v_or3_b32 v10, v10, v141, v142
    v_or3_b32 v10, v10, v143, v145
    v_or3_b32 v10, v10, v146, v147
    v_cmp_ne_u32_sdwa vcc, v10, v5 src0_sel:BYTE_0 src1_sel:DWORD
    s_cbranch_vccnz L_ra
    s_nop 0
    v_add_f32_dpp v10, v17, v16 row_ror:8 row_mask:0xf bank_mask:0x3
    s_nop 0
    v_add_f32_dpp v11, v21, v20 row_ror:8 row_mask:0xf bank_mask:0x3
    v_add_f32_dpp v10, v18, v19 row_ror:8 row_mask:0xf bank_mask:0xc
    s_nop 0
    v_add_f32_dpp v11, v22, v23 row_ror:8 row_mask:0xf bank_mask:0xc
    ds_write_b64 v2, v[10:11] offset:4096
    s_waitcnt lgkmcnt(0)
    s_barrier
    ds_read2st64_b32 v[16:17], v15 offset0:16 offset1:18
    ds_read2st64_b32 v[18:19], v15 offset0:20 offset1:22
    s_waitcnt lgkmcnt(0)
    v_pk_add_f32 v[16:17], v[16:17], v[18:19]
    v_add_f32 v16, v16, v17
    v_cndmask_b32 v16, 1.0, v16, s[52:53]
    v_cvt_f64_f32 v[18:19], v16
    v_add_f64 v[58:59], v[58:59], v[18:19]
    buffer_atomic_add_f64 v[18:19], v30, s[40:43], s60 offen sc0 sc1
    s_waitcnt vmcnt(0)
    v_add_f64 v[58:59], v[58:59], v[18:19]
    v_mov_b32_dpp v20, v19 quad_perm:[1,1,3,3] row_mask:0xf bank_mask:0xf
    v_cvt_f32_f64 v16, v[58:59]
    v_cmp_eq_u32 vcc, s54, v20
    v_cvt_pk_bf16_f32 v16, v16, v16
    s_and_b64 exec, vcc, s[52:53]
    s_cbranch_execz L_Ky
    buffer_store_short v16, v14, s[44:47], 0 offen
    s_cmp_lg_u32 s60, 16384
    s_cbranch_scc1 L_Ky
    s_and_b64 exec, exec, 1
    s_cbranch_execz L_Ky
    v_mov_b32 v6, s12
    buffer_store_dword v6, v5, s[40:43], 0 offen
L_Ky:
L_Kx:
    s_endpgm
L_ra:
    s_mov_b64 exec, vcc
    buffer_load_dwordx4 v[96:99], v1, s[40:43], s61 offen offset:0 sc1 nt
    buffer_load_dwordx4 v[100:103], v1, s[40:43], s61 offen offset:1024 sc1 nt
    buffer_load_dwordx4 v[104:107], v1, s[40:43], s61 offen offset:2048 sc1 nt
    buffer_load_dwordx4 v[108:111], v1, s[40:43], s61 offen offset:3072 sc1 nt
    s_mov_b64 exec, -1
    s_sub_u32 s15, s15, 1
    s_cbranch_scc0 L_ck
    s_endpgm
L_rh:
    buffer_load_dwordx2 v[28:29], v4, s[40:43], s55 offen sc1 nt
    s_waitcnt vmcnt(0)
    s_sub_u32 s15, s15, 1
    s_cbranch_scc0 L_ch
    s_endpgm
L_rq:
    ds_read_b32 v6, v5 offset:28
    s_waitcnt lgkmcnt(0)
    v_add_u32 v6, v6, v3
    buffer_load_dwordx4 v[16:19], v6, s[40:43], s52 offen sc1 nt
    buffer_load_dwordx4 v[20:23], v6, s[40:43], s53 offen sc1 nt
    s_waitcnt vmcnt(0)
    s_sub_u32 s15, s15, 1
    s_cbranch_scc0 L_cq
    s_endpgm
L_rz:
    s_sleep 8
    s_movk_i32 s14, 6144
    buffer_load_dword v57, v5, s[40:43], s14 offen sc1
    s_waitcnt vmcnt(0)
    s_sub_u32 s15, s15, 1
    s_cbranch_scc0 L_cz
    s_endpgm
L_ZERO:
    s_load_dword s13, s[40:41], 0
    s_waitcnt vmcnt(0) lgkmcnt(0)
    s_add_u32 s12, s13, 1
    v_mov_b32 v2, s12
    s_movk_i32 s14, 6144
    s_mov_b64 exec, 1
    buffer_store_dword v2, v4, s[40:43], s14 offen sc1
    s_endpgm
L_V:
    s_setprio 1
    v_lshrrev_b32 v2, 3, v0
    v_lshlrev_b32 v1, 12, v2
    v_and_b32 v2, 7, v0
    v_lshl_add_u32 v1, v2, 4, v1
    s_lshl_b32 s14, s8, 7
    v_add_u32 v1, s14, v1
    s_and_b32 s62, s9, 7
    s_lshl_b32 s62, s62, 9
    s_lshr_b32 s14, s9, 3
    s_lshl_b32 s14, s14, 15
    s_or_b32 s62, s62, s14
    s_waitcnt lgkmcnt(0)
    s_add_u32 s44, s20, s60
    s_addc_u32 s45, s21, 0
    s_mov_b32 s46, 131072
    s_mov_b32 s47, 0x20000
    s_mov_b32 s40, s38
    s_mov_b32 s41, s39
    s_mov_b32 s42, 2097152
    s_mov_b32 s43, 0x20000
    s_load_dword s13, s[40:41], 0
    s_mov_b32 s15, 131072
    s_mov_b32 s56, 0x05040100
    s_mov_b32 s57, 0x07060302
    s_mov_b32 s58, 0xffffff00
    s_mov_b32 s59, 1035512379
    v_and_b32 v6, 1, v0
    v_lshrrev_b32 v7, 4, v0
    v_lshl_add_u32 v6, v7, 1, v6
    v_lshlrev_b32 v6, 4, v6
    v_bfe_u32 v7, v0, 1, 1
    v_lshl_add_u32 v6, v7, 9, v6
    v_add_u32 v6, 2048, v6
    v_mov_b32 v2, 256
    v_mov_b32 v3, 256
    v_mov_b32 v4, 256
    v_mov_b32 v5, 256
    v_mov_b32_dpp v2, v6 quad_perm:[0,1,2,3] row_mask:0xf bank_mask:1
    v_mov_b32_dpp v3, v6 quad_perm:[0,1,2,3] row_mask:0xf bank_mask:2
    v_mov_b32_dpp v4, v6 quad_perm:[0,1,2,3] row_mask:0xf bank_mask:4
    v_mov_b32_dpp v5, v6 quad_perm:[0,1,2,3] row_mask:0xf bank_mask:8
    v_mov_b32 v6, 0
    v_mov_b32 v16, 1
    s_lshl_b32 s61, s4, 16
    s_lshl_b32 s14, s8, 13
    s_add_u32 s61, s61, s14
    s_bfe_u32 s14, s5, 0x20002
    s_lshl_b32 s14, s14, 10
    s_add_u32 s61, s61, s14
    s_and_b32 s14, s5, 3
    s_lshl_b32 s14, s14, 6
    s_add_u32 s61, s61, s14
    s_lshl_b32 s14, s6, 5
    s_add_u32 s61, s61, s14
    s_add_u32 s61, s61, 524288
    s_add_u32 s63, s61, 1048576
    s_mov_b32 s52, 0xffff
    s_mov_b32 s53, 0xffff
    s_xor_b32 s14, s62, 0
    buffer_load_dwordx4 v[40:43], v1, s[44:47], s14 offen nt
    s_xor_b32 s14, s62, 512
    buffer_load_dwordx4 v[44:47], v1, s[44:47], s14 offen nt
    s_xor_b32 s14, s62, 1024
    buffer_load_dwordx4 v[48:51], v1, s[44:47], s14 offen nt
    s_xor_b32 s14, s62, 1536
    buffer_load_dwordx4 v[52:55], v1, s[44:47], s14 offen nt
    s_xor_b32 s14, s62, 2048
    buffer_load_dwordx4 v[56:59], v1, s[44:47], s14 offen nt
    s_xor_b32 s14, s62, 2560
    buffer_load_dwordx4 v[60:63], v1, s[44:47], s14 offen nt
    s_xor_b32 s14, s62, 3072
    buffer_load_dwordx4 v[64:67], v1, s[44:47], s14 offen nt
    s_xor_b32 s14, s62, 3584
    buffer_load_dwordx4 v[68:71], v1, s[44:47], s14 offen nt
    s_xor_b32 s14, s62, 32768
    buffer_load_dwordx4 v[72:75], v1, s[44:47], s14 offen nt
    s_xor_b32 s14, s62, 33280
    buffer_load_dwordx4 v[76:79], v1, s[44:47], s14 offen nt
    s_xor_b32 s14, s62, 33792
    buffer_load_dwordx4 v[80:83], v1, s[44:47], s14 offen nt
    s_xor_b32 s14, s62, 34304
    buffer_load_dwordx4 v[84:87], v1, s[44:47], s14 offen nt
    s_xor_b32 s14, s62, 34816
    buffer_load_dwordx4 v[88:91], v1, s[44:47], s14 offen nt
    s_xor_b32 s14, s62, 35328
    buffer_load_dwordx4 v[92:95], v1, s[44:47], s14 offen nt
    s_xor_b32 s14, s62, 35840
    buffer_load_dwordx4 v[96:99], v1, s[44:47], s14 offen nt
    s_xor_b32 s14, s62, 36352
    buffer_load_dwordx4 v[100:103], v1, s[44:47], s14 offen nt
    s_xor_b32 s14, s62, 65536
    buffer_load_dwordx4 v[104:107], v1, s[44:47], s14 offen nt
    s_xor_b32 s14, s62, 66048
    buffer_load_dwordx4 v[108:111], v1, s[44:47], s14 offen nt
    s_xor_b32 s14, s62, 66560
    buffer_load_dwordx4 v[112:115], v1, s[44:47], s14 offen nt
    s_xor_b32 s14, s62, 67072
    buffer_load_dwordx4 v[116:119], v1, s[44:47], s14 offen nt
    s_xor_b32 s14, s62, 67584
    buffer_load_dwordx4 v[120:123], v1, s[44:47], s14 offen nt
    s_xor_b32 s14, s62, 68096
    buffer_load_dwordx4 v[124:127], v1, s[44:47], s14 offen nt
    s_xor_b32 s14, s62, 68608
    buffer_load_dwordx4 v[128:131], v1, s[44:47], s14 offen nt
    s_xor_b32 s14, s62, 69120
    buffer_load_dwordx4 v[132:135], v1, s[44:47], s14 offen nt
    s_xor_b32 s14, s62, 98304
    buffer_load_dwordx4 v[136:139], v1, s[44:47], s14 offen nt
    s_xor_b32 s14, s62, 98816
    buffer_load_dwordx4 v[140:143], v1, s[44:47], s14 offen nt
    s_xor_b32 s14, s62, 99328
    buffer_load_dwordx4 v[144:147], v1, s[44:47], s14 offen nt
    s_xor_b32 s14, s62, 99840
    buffer_load_dwordx4 v[148:151], v1, s[44:47], s14 offen nt
    s_xor_b32 s14, s62, 100352
    buffer_load_dwordx4 v[152:155], v1, s[44:47], s14 offen nt
    s_xor_b32 s14, s62, 100864
    buffer_load_dwordx4 v[156:159], v1, s[44:47], s14 offen nt
    s_xor_b32 s14, s62, 101376
    buffer_load_dwordx4 v[160:163], v1, s[44:47], s14 offen nt
    s_xor_b32 s14, s62, 101888
    buffer_load_dwordx4 v[164:167], v1, s[44:47], s14 offen nt
    s_mov_b64 exec, 1
    ds_add_u32 v6, v16 offset:36
    s_mov_b64 exec, -1
L_pad6:
    s_cbranch_execz L_pad7
L_sp13:
    ds_read_b32 v7, v6 offset:4
    s_waitcnt lgkmcnt(0)
    v_readfirstlane_b32 s14, v7
    s_cmp_ge_u32 s14, 4
    s_cbranch_scc1 L_sd14
    s_sleep 1
    s_sub_u32 s15, s15, 1
    s_cbranch_scc0 L_sp13
    s_endpgm
L_sd14:
    s_setprio 3
    ds_read_b128 v[24:27], v2 offset:0
    ds_read_b128 v[28:31], v3 offset:0
    ds_read_b128 v[32:35], v4 offset:0
    ds_read_b128 v[36:39], v5 offset:0
    s_waitcnt vmcnt(24) lgkmcnt(0)
    v_perm_b32 v16, v44, v40, s56
    v_perm_b32 v17, v52, v48, s56
    v_perm_b32 v18, v60, v56, s56
    v_perm_b32 v19, v68, v64, s56
    v_perm_b32 v20, v44, v40, s57
    v_perm_b32 v21, v52, v48, s57
    v_perm_b32 v22, v60, v56, s57
    v_perm_b32 v23, v68, v64, s57
    v_mfma_f32_16x16x32_bf16 v[8:11], v[24:27], v[16:19], 0
    s_nop 0
    v_mfma_f32_16x16x32_bf16 v[12:15], v[24:27], v[20:23], 0
    v_perm_b32 v16, v45, v41, s56
    v_perm_b32 v17, v53, v49, s56
    v_perm_b32 v18, v61, v57, s56
    v_perm_b32 v19, v69, v65, s56
    v_perm_b32 v20, v45, v41, s57
    v_perm_b32 v21, v53, v49, s57
    v_perm_b32 v22, v61, v57, s57
    v_perm_b32 v23, v69, v65, s57
    v_mfma_f32_16x16x32_bf16 v[8:11], v[28:31], v[16:19], v[8:11]
    s_nop 0
    v_mfma_f32_16x16x32_bf16 v[12:15], v[28:31], v[20:23], v[12:15]
    v_perm_b32 v16, v46, v42, s56
    v_perm_b32 v17, v54, v50, s56
    v_perm_b32 v18, v62, v58, s56
    v_perm_b32 v19, v70, v66, s56
    v_perm_b32 v20, v46, v42, s57
    v_perm_b32 v21, v54, v50, s57
    v_perm_b32 v22, v62, v58, s57
    v_perm_b32 v23, v70, v66, s57
    v_mfma_f32_16x16x32_bf16 v[8:11], v[32:35], v[16:19], v[8:11]
    s_nop 0
    v_mfma_f32_16x16x32_bf16 v[12:15], v[32:35], v[20:23], v[12:15]
    v_perm_b32 v16, v47, v43, s56
    v_perm_b32 v17, v55, v51, s56
    v_perm_b32 v18, v63, v59, s56
    v_perm_b32 v19, v71, v67, s56
    v_perm_b32 v20, v47, v43, s57
    v_perm_b32 v21, v55, v51, s57
    v_perm_b32 v22, v63, v59, s57
    v_perm_b32 v23, v71, v67, s57
    v_mfma_f32_16x16x32_bf16 v[8:11], v[36:39], v[16:19], v[8:11]
    s_nop 0
    v_mfma_f32_16x16x32_bf16 v[12:15], v[36:39], v[20:23], v[12:15]
    ds_read_b128 v[40:43], v2 offset:128
    ds_read_b128 v[44:47], v3 offset:128
    ds_read_b128 v[48:51], v4 offset:128
    ds_read_b128 v[52:55], v5 offset:128
    ds_read_b128 v[56:59], v2 offset:256
    ds_read_b128 v[60:63], v3 offset:256
    ds_read_b128 v[64:67], v4 offset:256
    ds_read_b128 v[68:71], v5 offset:256
    ds_read_b128 v[24:27], v2 offset:384
    ds_read_b128 v[28:31], v3 offset:384
    ds_read_b128 v[32:35], v4 offset:384
    ds_read_b128 v[36:39], v5 offset:384
    s_waitcnt vmcnt(16) lgkmcnt(0)
    v_perm_b32 v16, v76, v72, s56
    v_perm_b32 v17, v84, v80, s56
    v_perm_b32 v18, v92, v88, s56
    v_perm_b32 v19, v100, v96, s56
    v_perm_b32 v20, v76, v72, s57
    v_perm_b32 v21, v84, v80, s57
    v_perm_b32 v22, v92, v88, s57
    v_perm_b32 v23, v100, v96, s57
    v_mfma_f32_16x16x32_bf16 v[8:11], v[40:43], v[16:19], v[8:11]
    s_nop 0
    v_mfma_f32_16x16x32_bf16 v[12:15], v[40:43], v[20:23], v[12:15]
    v_perm_b32 v16, v77, v73, s56
    v_perm_b32 v17, v85, v81, s56
    v_perm_b32 v18, v93, v89, s56
    v_perm_b32 v19, v101, v97, s56
    v_perm_b32 v20, v77, v73, s57
    v_perm_b32 v21, v85, v81, s57
    v_perm_b32 v22, v93, v89, s57
    v_perm_b32 v23, v101, v97, s57
    v_mfma_f32_16x16x32_bf16 v[8:11], v[44:47], v[16:19], v[8:11]
    s_nop 0
    v_mfma_f32_16x16x32_bf16 v[12:15], v[44:47], v[20:23], v[12:15]
    v_perm_b32 v16, v78, v74, s56
    v_perm_b32 v17, v86, v82, s56
    v_perm_b32 v18, v94, v90, s56
    v_perm_b32 v19, v102, v98, s56
    v_perm_b32 v20, v78, v74, s57
    v_perm_b32 v21, v86, v82, s57
    v_perm_b32 v22, v94, v90, s57
    v_perm_b32 v23, v102, v98, s57
    v_mfma_f32_16x16x32_bf16 v[8:11], v[48:51], v[16:19], v[8:11]
    s_nop 0
    v_mfma_f32_16x16x32_bf16 v[12:15], v[48:51], v[20:23], v[12:15]
    v_perm_b32 v16, v79, v75, s56
    v_perm_b32 v17, v87, v83, s56
    v_perm_b32 v18, v95, v91, s56
    v_perm_b32 v19, v103, v99, s56
    v_perm_b32 v20, v79, v75, s57
    v_perm_b32 v21, v87, v83, s57
    v_perm_b32 v22, v95, v91, s57
    v_perm_b32 v23, v103, v99, s57
    v_mfma_f32_16x16x32_bf16 v[8:11], v[52:55], v[16:19], v[8:11]
    s_nop 0
    v_mfma_f32_16x16x32_bf16 v[12:15], v[52:55], v[20:23], v[12:15]
L_pad7:
    s_cbranch_execz L_pad8
    s_waitcnt vmcnt(8) lgkmcnt(0)
    v_perm_b32 v16, v108, v104, s56
    v_perm_b32 v17, v116, v112, s56
    v_perm_b32 v18, v124, v120, s56
    v_perm_b32 v19, v132, v128, s56
    v_perm_b32 v20, v108, v104, s57
    v_perm_b32 v21, v116, v112, s57
    v_perm_b32 v22, v124, v120, s57
    v_perm_b32 v23, v132, v128, s57
    v_mfma_f32_16x16x32_bf16 v[8:11], v[56:59], v[16:19], v[8:11]
    s_nop 0
    v_mfma_f32_16x16x32_bf16 v[12:15], v[56:59], v[20:23], v[12:15]
    v_perm_b32 v16, v109, v105, s56
    v_perm_b32 v17, v117, v113, s56
    v_perm_b32 v18, v125, v121, s56
    v_perm_b32 v19, v133, v129, s56
    v_perm_b32 v20, v109, v105, s57
    v_perm_b32 v21, v117, v113, s57
    v_perm_b32 v22, v125, v121, s57
    v_perm_b32 v23, v133, v129, s57
    v_mfma_f32_16x16x32_bf16 v[8:11], v[60:63], v[16:19], v[8:11]
    s_nop 0
    v_mfma_f32_16x16x32_bf16 v[12:15], v[60:63], v[20:23], v[12:15]
    v_perm_b32 v16, v110, v106, s56
    v_perm_b32 v17, v118, v114, s56
    v_perm_b32 v18, v126, v122, s56
    v_perm_b32 v19, v134, v130, s56
    v_perm_b32 v20, v110, v106, s57
    v_perm_b32 v21, v118, v114, s57
    v_perm_b32 v22, v126, v122, s57
    v_perm_b32 v23, v134, v130, s57
    v_mfma_f32_16x16x32_bf16 v[8:11], v[64:67], v[16:19], v[8:11]
    s_nop 0
    v_mfma_f32_16x16x32_bf16 v[12:15], v[64:67], v[20:23], v[12:15]
    v_perm_b32 v16, v111, v107, s56
    v_perm_b32 v17, v119, v115, s56
    v_perm_b32 v18, v127, v123, s56
    v_perm_b32 v19, v135, v131, s56
    v_perm_b32 v20, v111, v107, s57
    v_perm_b32 v21, v119, v115, s57
    v_perm_b32 v22, v127, v123, s57
    v_perm_b32 v23, v135, v131, s57
    v_mfma_f32_16x16x32_bf16 v[8:11], v[68:71], v[16:19], v[8:11]
    s_nop 0
    v_mfma_f32_16x16x32_bf16 v[12:15], v[68:71], v[20:23], v[12:15]
    s_add_u32 s12, s13, 1
    s_mul_i32 s92, s12, 0x01030507
    s_bfe_u32 s88, s92, 524288
    s_bfe_u32 s89, s92, 524296
    s_bfe_u32 s90, s92, 524304
    s_bfe_u32 s91, s92, 524312
    s_lshr_b32 s93, s92, 8
    s_and_b32 s94, s92, 0xffff
    s_lshr_b32 s95, s92, 16
L_sp15:
    ds_read_b32 v7, v6 offset:44
    s_waitcnt lgkmcnt(0)
    v_readfirstlane_b32 s14, v7
    s_cmp_ge_u32 s14, 1
    s_cbranch_scc1 L_sd16
    s_sleep 1
    s_sub_u32 s15, s15, 1
    s_cbranch_scc0 L_sp15
    s_endpgm
L_sd16:
    ds_read_b32 v7, v6 offset:28
    v_mov_b32 v2, 1
    v_bfe_u32 v4, v0, 3, 1
    v_and_b32 v1, 1, v0
    v_lshlrev_b32 v1, 4, v1
    v_lshl_add_u32 v1, v4, 15, v1
    v_bfe_u32 v4, v0, 1, 2
    v_lshl_add_u32 v1, v4, 8, v1
    v_lshrrev_b32 v4, 5, v0
    v_lshl_add_u32 v1, v4, 12, v1
    v_bfe_u32 v41, v0, 4, 1
    v_lshlrev_b32 v41, 4, v41
    v_bfe_u32 v40, s92, v41, 8
    v_bfe_u32 v41, s93, v41, 8
    s_waitcnt lgkmcnt(0)
    v_readfirstlane_b32 s54, v7
L_pad8:
    s_cbranch_execz L_end
    s_waitcnt vmcnt(6)
    v_perm_b32 v72, v140, v136, s56
    v_perm_b32 v76, v140, v136, s57
    v_perm_b32 v80, v141, v137, s56
    v_perm_b32 v84, v141, v137, s57
    v_perm_b32 v88, v142, v138, s56
    v_perm_b32 v92, v142, v138, s57
    v_perm_b32 v96, v143, v139, s56
    v_perm_b32 v100, v143, v139, s57
    s_waitcnt vmcnt(4)
    v_perm_b32 v73, v148, v144, s56
    v_perm_b32 v77, v148, v144, s57
    v_perm_b32 v81, v149, v145, s56
    v_perm_b32 v85, v149, v145, s57
    v_perm_b32 v89, v150, v146, s56
    v_perm_b32 v93, v150, v146, s57
    v_perm_b32 v97, v151, v147, s56
    v_perm_b32 v101, v151, v147, s57
    s_waitcnt vmcnt(2)
    v_perm_b32 v74, v156, v152, s56
    v_perm_b32 v78, v156, v152, s57
    v_perm_b32 v82, v157, v153, s56
    v_perm_b32 v86, v157, v153, s57
    v_perm_b32 v90, v158, v154, s56
    v_perm_b32 v94, v158, v154, s57
    v_perm_b32 v98, v159, v155, s56
    v_perm_b32 v102, v159, v155, s57
    s_waitcnt vmcnt(0)
    v_perm_b32 v75, v164, v160, s56
    v_perm_b32 v79, v164, v160, s57
    v_perm_b32 v83, v165, v161, s56
    v_perm_b32 v87, v165, v161, s57
    v_mfma_f32_16x16x32_bf16 v[8:11], v[24:27], v[72:75], v[8:11]
    v_mfma_f32_16x16x32_bf16 v[12:15], v[24:27], v[76:79], v[12:15]
    v_perm_b32 v91, v166, v162, s56
    v_perm_b32 v95, v166, v162, s57
    v_mfma_f32_16x16x32_bf16 v[8:11], v[28:31], v[80:83], v[8:11]
    v_mfma_f32_16x16x32_bf16 v[12:15], v[28:31], v[84:87], v[12:15]
    v_perm_b32 v99, v167, v163, s56
    v_perm_b32 v103, v167, v163, s57
    v_mfma_f32_16x16x32_bf16 v[8:11], v[32:35], v[88:91], v[8:11]
    v_mfma_f32_16x16x32_bf16 v[12:15], v[32:35], v[92:95], v[12:15]
    v_mfma_f32_16x16x32_bf16 v[8:11], v[36:39], v[96:99], v[8:11]
    v_mfma_f32_16x16x32_bf16 v[12:15], v[36:39], v[100:103], v[12:15]
    s_nop 6
    v_add_f32_dpp v4, v9, v8 row_ror:8 row_mask:0xf bank_mask:0x3
    v_add_f32_dpp v5, v13, v12 row_ror:8 row_mask:0xf bank_mask:0x3
    s_nop 0
    v_add_f32_dpp v4, v10, v11 row_ror:8 row_mask:0xf bank_mask:0xc
    v_add_f32_dpp v5, v14, v15 row_ror:8 row_mask:0xf bank_mask:0xc
    v_and_or_b32 v16, v4, s58, v40
    v_and_or_b32 v17, v5, s58, v41
    s_nop 0
    v_permlane16_swap_b32 v16, v18
    v_permlane16_swap_b32 v17, v19
    s_mov_b64 exec, s[52:53]
    buffer_store_dwordx4 v[16:19], v1, s[40:43], s61 offen
    s_cmp_eq_u32 s54, 0
    s_cbranch_scc1 L_onear
    buffer_store_dwordx4 v[16:19], v1, s[40:43], s63 offen sc1
L_onear:
    s_mov_b64 exec, 1
    ds_add_u32 v6, v2 offset:32
    s_endpgm
L_S2:
    s_mov_b32 s40, s38
    s_mov_b32 s41, s39
    s_mov_b32 s42, 2097152
    s_mov_b32 s43, 0x20000
    s_load_dword s13, s[40:41], 0
    s_mov_b32 s15, 131072
    s_mov_b32 s56, 0x05040100
    s_mov_b32 s57, 0x07060302
    s_mov_b32 s58, 0xffffff00
    s_mov_b32 s59, 1035512379
    s_waitcnt vmcnt(16)
    v_lshlrev_b32 v96, 16, v8
    v_and_b32 v97, 0xffff0000, v8
    v_lshlrev_b32 v98, 16, v9
    v_and_b32 v99, 0xffff0000, v9
    v_lshlrev_b32 v100, 16, v10
    v_and_b32 v101, 0xffff0000, v10
    v_lshlrev_b32 v102, 16, v11
    v_and_b32 v103, 0xffff0000, v11
    v_lshlrev_b32 v104, 16, v12
    v_and_b32 v105, 0xffff0000, v12
    v_lshlrev_b32 v106, 16, v13
    v_and_b32 v107, 0xffff0000, v13
    v_lshlrev_b32 v108, 16, v14
    v_and_b32 v109, 0xffff0000, v14
    v_lshlrev_b32 v110, 16, v15
    v_and_b32 v111, 0xffff0000, v15
    v_add_f32 v8, v96, v97
    v_add_f32 v9, v98, v99
    v_add_f32 v10, v100, v101
    v_add_f32 v11, v102, v103
    v_add_f32 v12, v104, v105
    v_add_f32 v13, v106, v107
    v_add_f32 v14, v108, v109
    v_add_f32 v15, v110, v111
    v_add_f32 v8, v8, v12
    v_add_f32 v9, v9, v13
    v_add_f32 v10, v10, v14
    v_add_f32 v11, v11, v15
    v_add_f32 v8, v8, v10
    v_add_f32 v9, v9, v11
    v_add_f32 v8, v8, v9
    s_nop 1
    v_add_f32_dpp v8, v8, v8 quad_perm:[1,0,3,2] row_mask:0xf bank_mask:0xf
    s_nop 1
    v_add_f32_dpp v8, v8, v8 row_ror:4 row_mask:0xf bank_mask:0xf
    s_nop 1
    v_add_f32_dpp v8, v8, v8 row_ror:8 row_mask:0xf bank_mask:0xf
    v_mov_b32 v9, v8
    s_nop 1
    v_permlane16_swap_b32 v9, v8
    v_add_f32 v8, v9, v8
    v_mov_b32 v9, v8
    s_nop 1
    v_permlane32_swap_b32 v9, v8
    v_add_f32 v8, v9, v8
    v_mul_f32 v8, 0x3b124925, v8
    v_sub_f32 v96, v96, v8
    v_sub_f32 v97, v97, v8
    v_sub_f32 v98, v98, v8
    v_sub_f32 v99, v99, v8
    v_sub_f32 v100, v100, v8
    v_sub_f32 v101, v101, v8
    v_sub_f32 v102, v102, v8
    v_sub_f32 v103, v103, v8
    v_sub_f32 v104, v104, v8
    v_sub_f32 v105, v105, v8
    v_sub_f32 v106, v106, v8
    v_sub_f32 v107, v107, v8
    v_sub_f32 v108, v108, v8
    v_sub_f32 v109, v109, v8
    v_sub_f32 v110, v110, v8
    v_sub_f32 v111, v111, v8
    v_mul_f32 v10, v96, v96
    v_mul_f32 v11, v97, v97
    v_fmac_f32 v10, v98, v98
    v_fmac_f32 v11, v99, v99
    v_fmac_f32 v10, v100, v100
    v_fmac_f32 v11, v101, v101
    v_fmac_f32 v10, v102, v102
    v_fmac_f32 v11, v103, v103
    v_fmac_f32 v10, v104, v104
    v_fmac_f32 v11, v105, v105
    v_fmac_f32 v10, v106, v106
    v_fmac_f32 v11, v107, v107
    v_fmac_f32 v10, v108, v108
    v_fmac_f32 v11, v109, v109
    v_fmac_f32 v10, v110, v110
    v_fmac_f32 v11, v111, v111
    v_add_f32 v10, v10, v11
    v_cndmask_b32 v10, 0, v10, vcc
    s_nop 1
    v_add_f32_dpp v10, v10, v10 quad_perm:[1,0,3,2] row_mask:0xf bank_mask:0xf
    s_nop 1
    v_add_f32_dpp v10, v10, v10 row_ror:4 row_mask:0xf bank_mask:0xf
    s_nop 1
    v_add_f32_dpp v10, v10, v10 row_ror:8 row_mask:0xf bank_mask:0xf
    v_mov_b32 v9, v10
    s_nop 1
    v_permlane16_swap_b32 v9, v10
    v_add_f32 v10, v9, v10
    v_mov_b32 v9, v10
    s_nop 1
    v_permlane32_swap_b32 v9, v10
    v_add_f32 v10, v9, v10
    v_mul_f32 v10, 0x3b124925, v10
    v_cvt_pk_bf16_f32 v8, v8, v8
    v_and_b32 v8, 0xffff0000, v8
    v_cvt_pk_bf16_f32 v10, v10, v10
    v_and_b32 v10, 0xffff0000, v10
    v_add_f32 v10, 0x3727c5ac, v10
    v_cvt_pk_bf16_f32 v10, v10, v10
    v_and_b32 v10, 0xffff0000, v10
    v_sqrt_f32 v10, v10
    s_nop 0
    v_cvt_pk_bf16_f32 v10, v10, v10
    v_and_b32 v10, 0xffff0000, v10
    v_rcp_f32 v11, v10
    s_nop 0
    v_fma_f32 v12, -v10, v11, 1.0
    v_fma_f32 v11, v12, v11, v11
L_pad9:
    s_cbranch_execz L_pad10
    s_waitcnt vmcnt(14)
    v_lshlrev_b32 v96, 16, v16
    v_and_b32 v97, 0xffff0000, v16
    v_lshlrev_b32 v98, 16, v17
    v_and_b32 v99, 0xffff0000, v17
    v_lshlrev_b32 v100, 16, v18
    v_and_b32 v101, 0xffff0000, v18
    v_lshlrev_b32 v102, 16, v19
    v_and_b32 v103, 0xffff0000, v19
    v_lshlrev_b32 v104, 16, v20
    v_and_b32 v105, 0xffff0000, v20
    v_lshlrev_b32 v106, 16, v21
    v_and_b32 v107, 0xffff0000, v21
    v_lshlrev_b32 v108, 16, v22
    v_and_b32 v109, 0xffff0000, v22
    v_sub_f32 v96, v96, v8
    v_sub_f32 v97, v97, v8
    v_sub_f32 v98, v98, v8
    v_sub_f32 v99, v99, v8
    v_sub_f32 v100, v100, v8
    v_sub_f32 v101, v101, v8
    v_sub_f32 v102, v102, v8
    v_sub_f32 v103, v103, v8
    v_sub_f32 v104, v104, v8
    v_sub_f32 v105, v105, v8
    v_sub_f32 v106, v106, v8
    v_sub_f32 v107, v107, v8
    v_sub_f32 v108, v108, v8
    v_sub_f32 v109, v109, v8
    v_cvt_pk_bf16_f32 v16, v96, v97
    v_cvt_pk_bf16_f32 v17, v98, v99
    v_cvt_pk_bf16_f32 v18, v100, v101
    v_cvt_pk_bf16_f32 v19, v102, v103
    v_cvt_pk_bf16_f32 v20, v104, v105
    v_cvt_pk_bf16_f32 v21, v106, v107
    v_cvt_pk_bf16_f32 v22, v108, v109
    v_lshlrev_b32 v96, 16, v16
    v_and_b32 v97, 0xffff0000, v16
    v_lshlrev_b32 v98, 16, v17
    v_and_b32 v99, 0xffff0000, v17
    v_lshlrev_b32 v100, 16, v18
    v_and_b32 v101, 0xffff0000, v18
    v_lshlrev_b32 v102, 16, v19
    v_and_b32 v103, 0xffff0000, v19
    v_lshlrev_b32 v104, 16, v20
    v_and_b32 v105, 0xffff0000, v20
    v_lshlrev_b32 v106, 16, v21
    v_and_b32 v107, 0xffff0000, v21
    v_lshlrev_b32 v108, 16, v22
    v_and_b32 v109, 0xffff0000, v22
    v_mul_f32 v96, v96, v11
    v_mul_f32 v97, v97, v11
    v_mul_f32 v98, v98, v11
    v_mul_f32 v99, v99, v11
    v_mul_f32 v100, v100, v11
    v_mul_f32 v101, v101, v11
    v_mul_f32 v102, v102, v11
    v_mul_f32 v103, v103, v11
    v_mul_f32 v104, v104, v11
    v_mul_f32 v105, v105, v11
    v_mul_f32 v106, v106, v11
    v_mul_f32 v107, v107, v11
    v_mul_f32 v108, v108, v11
    v_mul_f32 v109, v109, v11
    v_cvt_pk_bf16_f32 v16, v96, v97
    v_cvt_pk_bf16_f32 v17, v98, v99
    v_cvt_pk_bf16_f32 v18, v100, v101
    v_cvt_pk_bf16_f32 v19, v102, v103
    v_cvt_pk_bf16_f32 v20, v104, v105
    v_cvt_pk_bf16_f32 v21, v106, v107
    v_cvt_pk_bf16_f32 v22, v108, v109
    v_mov_b32 v23, 0
    v_mov_b32 v95, 0
    v_mov_b32 v31, 0
    s_waitcnt vmcnt(0) lgkmcnt(0)
    s_add_u32 s12, s13, 1
    s_mul_i32 s92, s12, 0x01030507
    s_bfe_u32 s88, s92, 524288
    s_bfe_u32 s89, s92, 524296
    s_bfe_u32 s90, s92, 524304
    s_bfe_u32 s91, s92, 524312
    s_lshr_b32 s93, s92, 8
    s_and_b32 s94, s92, 0xffff
    s_lshr_b32 s95, s92, 16
    v_perm_b32 v88, v36, v32, s56
    v_perm_b32 v89, v44, v40, s56
    v_perm_b32 v90, v52, v48, s56
    v_perm_b32 v91, v60, v56, s56
    v_perm_b32 v92, v68, v64, s56
    v_perm_b32 v93, v76, v72, s56
    v_perm_b32 v94, v84, v80, s56
    v_mfma_f32_16x16x32_bf16 v[112:115], v[16:19], v[88:91], 0
    s_nop 0
    v_mfma_f32_16x16x32_bf16 v[112:115], v[20:23], v[92:95], v[112:115]
    v_perm_b32 v24, v36, v32, s57
    v_perm_b32 v25, v44, v40, s57
    v_perm_b32 v26, v52, v48, s57
    v_perm_b32 v27, v60, v56, s57
    v_perm_b32 v28, v68, v64, s57
    v_perm_b32 v29, v76, v72, s57
    v_perm_b32 v30, v84, v80, s57
    v_mfma_f32_16x16x32_bf16 v[116:119], v[16:19], v[24:27], 0
    s_nop 0
    v_mfma_f32_16x16x32_bf16 v[116:119], v[20:23], v[28:31], v[116:119]
    v_perm_b32 v88, v37, v33, s56
    v_perm_b32 v89, v45, v41, s56
    v_perm_b32 v90, v53, v49, s56
    v_perm_b32 v91, v61, v57, s56
    v_perm_b32 v92, v69, v65, s56
    v_perm_b32 v93, v77, v73, s56
    v_perm_b32 v94, v85, v81, s56
    v_mfma_f32_16x16x32_bf16 v[120:123], v[16:19], v[88:91], 0
    s_nop 0
    v_mfma_f32_16x16x32_bf16 v[120:123], v[20:23], v[92:95], v[120:123]
    v_perm_b32 v24, v37, v33, s57
    v_perm_b32 v25, v45, v41, s57
    v_perm_b32 v26, v53, v49, s57
    v_perm_b32 v27, v61, v57, s57
    v_perm_b32 v28, v69, v65, s57
    v_perm_b32 v29, v77, v73, s57
    v_perm_b32 v30, v85, v81, s57
    v_mfma_f32_16x16x32_bf16 v[124:127], v[16:19], v[24:27], 0
    s_nop 0
    v_mfma_f32_16x16x32_bf16 v[124:127], v[20:23], v[28:31], v[124:127]
    v_perm_b32 v88, v38, v34, s56
    v_perm_b32 v89, v46, v42, s56
    v_perm_b32 v90, v54, v50, s56
    v_perm_b32 v91, v62, v58, s56
    v_perm_b32 v92, v70, v66, s56
    v_perm_b32 v93, v78, v74, s56
    v_perm_b32 v94, v86, v82, s56
    v_mfma_f32_16x16x32_bf16 v[128:131], v[16:19], v[88:91], 0
    s_nop 0
    v_mfma_f32_16x16x32_bf16 v[128:131], v[20:23], v[92:95], v[128:131]
    v_perm_b32 v24, v38, v34, s57
    v_perm_b32 v25, v46, v42, s57
    v_perm_b32 v26, v54, v50, s57
    v_perm_b32 v27, v62, v58, s57
    v_perm_b32 v28, v70, v66, s57
    v_perm_b32 v29, v78, v74, s57
    v_perm_b32 v30, v86, v82, s57
    v_mfma_f32_16x16x32_bf16 v[132:135], v[16:19], v[24:27], 0
    s_nop 0
    v_mfma_f32_16x16x32_bf16 v[132:135], v[20:23], v[28:31], v[132:135]
    v_perm_b32 v88, v39, v35, s56
    v_perm_b32 v89, v47, v43, s56
    v_perm_b32 v90, v55, v51, s56
    v_perm_b32 v91, v63, v59, s56
    v_perm_b32 v92, v71, v67, s56
    v_perm_b32 v93, v79, v75, s56
    v_perm_b32 v94, v87, v83, s56
    v_mfma_f32_16x16x32_bf16 v[136:139], v[16:19], v[88:91], 0
    s_nop 0
    v_mfma_f32_16x16x32_bf16 v[136:139], v[20:23], v[92:95], v[136:139]
    v_perm_b32 v24, v39, v35, s57
    v_perm_b32 v25, v47, v43, s57
    v_perm_b32 v26, v55, v51, s57
    v_perm_b32 v27, v63, v59, s57
    v_perm_b32 v28, v71, v67, s57
    v_perm_b32 v29, v79, v75, s57
    v_perm_b32 v30, v87, v83, s57
    v_mfma_f32_16x16x32_bf16 v[140:143], v[16:19], v[24:27], 0
    s_nop 0
    v_mfma_f32_16x16x32_bf16 v[140:143], v[20:23], v[28:31], v[140:143]
L_pad10:
    s_cbranch_execz L_pad1
    s_cmp_eq_u32 s3, 1
    s_cbranch_scc1 L_A1post
    v_and_b32 v5, 7, v0
    v_lshlrev_b32 v5, 4, v5
    v_lshrrev_b32 v6, 5, v0
    v_lshl_add_u32 v5, v6, 7, v5
    v_bfe_u32 v6, v0, 3, 1
    v_lshl_add_u32 v5, v6, 13, v5
    v_bfe_u32 v2, v0, 4, 1
    v_lshlrev_b32 v2, 4, v2
    v_bfe_u32 v1, s92, v2, 8
    v_bfe_u32 v2, s93, v2, 8
    v_add_f32_dpp v8, v113, v112 row_ror:8 row_mask:1 bank_mask:0x3
    v_add_f32_dpp v9, v117, v116 row_ror:8 row_mask:1 bank_mask:0x3
    s_nop 0
    v_add_f32_dpp v8, v114, v115 row_ror:8 row_mask:1 bank_mask:0xc
    v_add_f32_dpp v9, v118, v119 row_ror:8 row_mask:1 bank_mask:0xc
    s_nop 0
    v_add_f32_dpp v8, v121, v120 row_ror:8 row_mask:2 bank_mask:0x3
    v_add_f32_dpp v9, v125, v124 row_ror:8 row_mask:2 bank_mask:0x3
    s_nop 0
    v_add_f32_dpp v8, v122, v123 row_ror:8 row_mask:2 bank_mask:0xc
    v_add_f32_dpp v9, v126, v127 row_ror:8 row_mask:2 bank_mask:0xc
    s_nop 0
    v_add_f32_dpp v8, v129, v128 row_ror:8 row_mask:4 bank_mask:0x3
    v_add_f32_dpp v9, v133, v132 row_ror:8 row_mask:4 bank_mask:0x3
    s_nop 0
    v_add_f32_dpp v8, v130, v131 row_ror:8 row_mask:4 bank_mask:0xc
    v_add_f32_dpp v9, v134, v135 row_ror:8 row_mask:4 bank_mask:0xc
    s_nop 0
    v_add_f32_dpp v8, v137, v136 row_ror:8 row_mask:8 bank_mask:0x3
    v_add_f32_dpp v9, v141, v140 row_ror:8 row_mask:8 bank_mask:0x3
    s_nop 0
    v_add_f32_dpp v8, v138, v139 row_ror:8 row_mask:8 bank_mask:0xc
    v_add_f32_dpp v9, v142, v143 row_ror:8 row_mask:8 bank_mask:0xc
    v_add_u32 v8, 0x80, v8
    v_add_u32 v9, 0x80, v9
    v_and_or_b32 v12, v8, s58, v1
    v_and_or_b32 v13, v9, s58, v2
    s_nop 0
    v_permlane16_swap_b32 v12, v14
    v_permlane16_swap_b32 v13, v15
    s_lshl_b32 s14, s4, 14
    s_lshl_b32 s62, s61, 11
    s_add_u32 s14, s14, s62
    s_and_b32 s62, s5, 7
    s_lshl_b32 s62, s62, 8
    s_add_u32 s14, s14, s62
    s_add_u32 s62, s14, 65536
    s_mov_b32 exec_lo, 0xffff
    s_mov_b32 exec_hi, 0xffff
    buffer_store_dwordx4 v[12:15], v5, s[40:43], s62 offen
    v_mov_b32 v6, 0
L_sp17:
    ds_read_b32 v7, v6 offset:44
    s_waitcnt lgkmcnt(0)
    v_readfirstlane_b32 s14, v7
    s_cmp_ge_u32 s14, 1
    s_cbranch_scc1 L_sd18
    s_sleep 8
    s_sub_u32 s15, s15, 1
    s_cbranch_scc0 L_sp17
    s_endpgm
L_sd18:
    ds_read_b32 v7, v6 offset:28
    s_waitcnt lgkmcnt(0)
    v_readfirstlane_b32 s54, v7
    s_cmp_eq_u32 s54, 0
    s_cbranch_scc1 L_qnear
    s_add_u32 s62, s62, s54
    buffer_store_dwordx4 v[12:15], v5, s[40:43], s62 offen sc1
L_qnear:
    s_endpgm
L_A1post:
    v_lshlrev_b32 v5, 4, v0
    v_mov_b32 v1, 0xff
    s_lshl3_add_u32 s62, s60, s61
    s_lshl_b32 s62, s62, 10
    s_add_u32 s62, s62, 196608
    s_nop 4
    v_mov_b32_dpp v8, v112 quad_perm:[0,1,2,3] row_mask:1 bank_mask:0xf
    v_mov_b32_dpp v9, v116 quad_perm:[0,1,2,3] row_mask:1 bank_mask:0xf
    v_mov_b32_dpp v10, v114 quad_perm:[0,1,2,3] row_mask:1 bank_mask:0xf
    v_mov_b32_dpp v11, v118 quad_perm:[0,1,2,3] row_mask:1 bank_mask:0xf
    v_mov_b32_dpp v8, v120 quad_perm:[0,1,2,3] row_mask:2 bank_mask:0xf
    v_mov_b32_dpp v9, v124 quad_perm:[0,1,2,3] row_mask:2 bank_mask:0xf
    v_mov_b32_dpp v10, v122 quad_perm:[0,1,2,3] row_mask:2 bank_mask:0xf
    v_mov_b32_dpp v11, v126 quad_perm:[0,1,2,3] row_mask:2 bank_mask:0xf
    v_mov_b32_dpp v8, v128 quad_perm:[0,1,2,3] row_mask:4 bank_mask:0xf
    v_mov_b32_dpp v9, v132 quad_perm:[0,1,2,3] row_mask:4 bank_mask:0xf
    v_mov_b32_dpp v10, v130 quad_perm:[0,1,2,3] row_mask:4 bank_mask:0xf
    v_mov_b32_dpp v11, v134 quad_perm:[0,1,2,3] row_mask:4 bank_mask:0xf
    v_mov_b32_dpp v8, v136 quad_perm:[0,1,2,3] row_mask:8 bank_mask:0xf
    v_mov_b32_dpp v9, v140 quad_perm:[0,1,2,3] row_mask:8 bank_mask:0xf
    v_mov_b32_dpp v10, v138 quad_perm:[0,1,2,3] row_mask:8 bank_mask:0xf
    v_mov_b32_dpp v11, v142 quad_perm:[0,1,2,3] row_mask:8 bank_mask:0xf
    v_add_u32 v8, 0x80, v8
    v_add_u32 v9, 0x80, v9
    v_add_u32 v10, 0x80, v10
    v_add_u32 v11, 0x80, v11
    v_bfi_b32 v8, v1, s88, v8
    v_bfi_b32 v9, v1, s89, v9
    v_bfi_b32 v10, v1, s90, v10
    v_bfi_b32 v11, v1, s91, v11
    buffer_store_dwordx4 v[8:11], v5, s[40:43], s62 offen
    v_mov_b32 v6, 0
L_sp19:
    ds_read_b32 v7, v6 offset:44
    s_waitcnt lgkmcnt(0)
    v_readfirstlane_b32 s14, v7
    s_cmp_ge_u32 s14, 1
    s_cbranch_scc1 L_sd20
    s_sleep 8
    s_sub_u32 s15, s15, 1
    s_cbranch_scc0 L_sp19
    s_endpgm
L_sd20:
    ds_read_b32 v7, v6 offset:28
    s_waitcnt lgkmcnt(0)
    v_readfirstlane_b32 s54, v7
    s_cmp_eq_u32 s54, 0
    s_cbranch_scc1 L_fnear
    s_add_u32 s62, s62, s54
    buffer_store_dwordx4 v[8:11], v5, s[40:43], s62 offen sc1
L_fnear:
    s_cmp_ge_u32 s5, 16
    s_cbranch_scc1 L_end
    v_and_b32 v5, 15, v0
    v_lshlrev_b32 v5, 4, v5
    v_lshrrev_b32 v3, 4, v0
    v_lshl_add_u32 v5, v3, 10, v5
    s_lshr_b32 s14, s5, 2
    s_lshl2_add_u32 s60, s4, s14
    s_lshl_b32 s60, s60, 13
    s_and_b32 s14, s5, 3
    s_lshl_b32 s14, s14, 8
    s_add_u32 s60, s60, s14
    s_add_u32 s60, s60, 196608
    s_add_u32 s60, s60, s54
    s_add_u32 s61, s60, 4096
    v_and_b32 v4, 7, v0
    v_lshlrev_b32 v4, 3, v4
    v_lshrrev_b32 v3, 5, v0
    v_lshl_add_u32 v4, v3, 6, v4
    s_lshl4_add_u32 s62, s4, s5
    s_lshl_b32 s62, s62, 7
    s_add_u32 s62, s62, 425984
L_pf:
    buffer_load_dwordx4 v[32:35], v5, s[40:43], s60 offen sc1 nt
    buffer_load_dwordx4 v[36:39], v5, s[40:43], s61 offen sc1 nt
    s_waitcnt vmcnt(0)
    v_xor_b32 v32, s88, v32
    v_xor_b32 v33, s89, v33
    v_xor_b32 v34, s90, v34
    v_xor_b32 v35, s91, v35
    v_xor_b32 v36, s88, v36
    v_xor_b32 v37, s89, v37
    v_xor_b32 v38, s90, v38
    v_xor_b32 v39, s91, v39
    v_or_b32 v8, v32, v33
    v_or3_b32 v8, v8, v34, v35
    v_or3_b32 v8, v8, v36, v37
    v_or3_b32 v8, v8, v38, v39
    v_and_b32 v8, 0xff, v8
    v_cmp_ne_u32 vcc, 0, v8
    s_cbranch_vccnz L_rf
    v_add_f32 v32, v32, v36
    v_add_f32 v33, v33, v37
    v_add_f32 v34, v34, v38
    v_add_f32 v35, v35, v39
    s_nop 0
    v_permlane32_swap_b32 v32, v34
    v_permlane32_swap_b32 v33, v35
    v_add_f32 v32, v32, v34
    v_add_f32 v33, v33, v35
    v_mov_b32 v34, v32
    s_nop 1
    v_permlane16_swap_b32 v34, v32
    v_add_f32 v32, v34, v32
    v_mov_b32 v35, v33
    s_nop 1
    v_permlane16_swap_b32 v35, v33
    v_add_f32 v33, v35, v33
    v_cvt_pk_bf16_f32 v32, v32, v32
    v_and_b32 v32, 0xffff0000, v32
    v_cvt_pk_bf16_f32 v33, v33, v33
    v_and_b32 v33, 0xffff0000, v33
    v_mov_b32_dpp v36, v32 row_ror:8 row_mask:0xf bank_mask:0xf
    s_nop 0
    v_mov_b32_dpp v37, v33 row_ror:8 row_mask:0xf bank_mask:0xf
    v_mul_f32 v8, v32, v32
    v_mul_f32 v9, v33, v33
    s_mov_b32 s14, 0x3d372713
    v_fma_f32 v8, v8, s14, 1.0
    v_fma_f32 v9, v9, s14, 1.0
    v_mul_f32 v8, v8, v32
    v_mul_f32 v9, v9, v33
    v_mul_f32 v8, 0xc0135761, v8
    v_mul_f32 v9, 0xc0135761, v9
    v_exp_f32 v8, v8
    v_exp_f32 v9, v9
    v_add_f32 v8, 1.0, v8
    v_add_f32 v9, 1.0, v9
    v_rcp_f32 v8, v8
    v_rcp_f32 v9, v9
    v_mul_f32 v8, v8, v32
    v_mul_f32 v9, v9, v33
    v_cvt_pk_bf16_f32 v8, v8, v8
    v_and_b32 v8, 0xffff0000, v8
    v_cvt_pk_bf16_f32 v9, v9, v9
    v_and_b32 v9, 0xffff0000, v9
    v_mul_f32 v8, v8, v36
    v_mul_f32 v9, v9, v37
    v_cvt_pk_bf16_f32 v8, v8, v8
    v_and_b32 v8, 0xffff0000, v8
    v_cvt_pk_bf16_f32 v9, v9, v9
    v_and_b32 v9, 0xffff0000, v9
    v_or_b32 v8, s94, v8
    v_or_b32 v9, s95, v9
    s_mov_b32 exec_lo, 0xff
    s_mov_b32 exec_hi, 0xff
    s_cmp_lg_u32 s54, 0
    s_cbranch_scc1 L_hfar
    buffer_store_dwordx2 v[8:9], v4, s[40:43], s62 offen
    s_endpgm
L_hfar:
    s_add_u32 s62, s62, s54
    buffer_store_dwordx2 v[8:9], v4, s[40:43], s62 offen sc1
    s_endpgm
L_rf:
    s_sleep 8
    s_sub_u32 s15, s15, 1
    s_cbranch_scc0 L_pf
    s_endpgm
L_A3:
    s_setprio 3
    s_mov_b32 s40, s38
    s_mov_b32 s41, s39
    s_mov_b32 s42, 2097152
    s_mov_b32 s43, 0x20000
    s_load_dword s13, s[40:41], 0
    s_mov_b32 s15, 131072
    s_mov_b32 s56, 0x05040100
    s_mov_b32 s57, 0x07060302
    s_mov_b32 s58, 0xffffff00
    s_mov_b32 s59, 1035512379
    s_mov_b32 s44, s36
    s_mov_b32 s45, s37
    s_mov_b32 s46, 256
    s_mov_b32 s47, 0x20000
    s_getreg_b32 s60, hwreg(HW_REG_XCC_ID, 0, 4)
    s_lshl_b32 s61, s4, 7
    s_add_u32 s61, s61, 4096
    s_lshl2_add_u32 s62, s5, s61
    v_mov_b32 v6, 0
    v_lshlrev_b32 v4, 2, v0
    s_waitcnt lgkmcnt(0)
    s_add_u32 s12, s13, 1
    s_mul_i32 s92, s12, 0x01030507
    s_bfe_u32 s88, s92, 524288
    s_bfe_u32 s89, s92, 524296
    s_bfe_u32 s90, s92, 524304
    s_bfe_u32 s91, s92, 524312
    s_lshr_b32 s93, s92, 8
    s_and_b32 s94, s92, 0xffff
    s_lshr_b32 s95, s92, 16
    s_lshl4_add_u32 s14, s12, s60
    v_mov_b32 v2, s14
    s_mov_b64 exec, 1
    buffer_store_dword v2, v6, s[40:43], s62 offen
    s_mov_b64 exec, -1
    v_bfe_u32 v21, v0, 5, 1
    v_lshlrev_b32 v21, 4, v21
    v_bfe_u32 v20, s92, v21, 8
    v_bfe_u32 v21, s93, v21, 8
L_sp21:
    ds_read_b32 v7, v6 offset:40
    s_waitcnt lgkmcnt(0)
    v_readfirstlane_b32 s14, v7
    s_cmp_ge_u32 s14, 4
    s_cbranch_scc1 L_sd22
    s_sleep 8
    s_sub_u32 s15, s15, 1
    s_cbranch_scc0 L_sp21
    s_endpgm
L_sd22:
    s_mov_b32 exec_hi, 0
    s_mov_b32 s63, 5
    s_mov_b32 s54, 0
L_pi:
    buffer_load_dword v3, v4, s[40:43], s61 offen sc1 nt
    s_waitcnt vmcnt(0)
    v_cmp_ne_u32 vcc, v2, v3
    s_cbranch_vccnz L_pifail
L_pidone:
    v_mov_b32 v2, s54
    v_mov_b32 v7, 1
    ds_write_b32 v6, v2 offset:28
    ds_write_b32 v6, v7 offset:44
    s_mov_b64 exec, -1
    v_lshlrev_b32 v5, 4, v0
    v_lshrrev_b32 v4, 5, v0
    v_lshlrev_b32 v4, 2, v4
L_sp23:
    ds_read_b32 v7, v6 offset:4
    s_waitcnt lgkmcnt(0)
    v_readfirstlane_b32 s14, v7
    s_cmp_ge_u32 s14, 4
    s_cbranch_scc1 L_sd24
    s_sleep 4
    s_sub_u32 s15, s15, 1
    s_cbranch_scc0 L_sp23
    s_endpgm
L_sd24:
    ds_read_b128 v[8:11], v5 offset:2048
    ds_read_b32 v16, v4 offset:16
    s_waitcnt lgkmcnt(0)
    v_lshlrev_b32 v12, 16, v8
    v_lshlrev_b32 v13, 16, v9
    v_lshlrev_b32 v14, 16, v10
    v_lshlrev_b32 v15, 16, v11
    v_and_b32 v8, 0xffff0000, v8
    v_and_b32 v9, 0xffff0000, v9
    v_and_b32 v10, 0xffff0000, v10
    v_and_b32 v11, 0xffff0000, v11
    v_add_f32 v8, v8, v12
    v_add_f32 v9, v9, v13
    v_add_f32 v10, v10, v14
    v_add_f32 v11, v11, v15
    v_add_f32 v8, v8, v9
    v_add_f32 v10, v10, v11
    v_add_f32 v17, v8, v10
    v_mov_b32 v13, v17
    s_nop 1
    v_permlane16_swap_b32 v13, v17
    v_add_f32 v17, v13, v17
    s_nop 1
    v_add_f32_dpp v17, v17, v17 row_ror:8 row_mask:0xf bank_mask:0xf
    s_nop 1
    v_add_f32_dpp v17, v17, v17 row_ror:4 row_mask:0xf bank_mask:0xf
    s_nop 1
    v_add_f32_dpp v17, v17, v17 row_ror:2 row_mask:0xf bank_mask:0xf
    s_nop 1
    v_add_f32_dpp v17, v17, v17 row_ror:1 row_mask:0xf bank_mask:0xf
    v_and_or_b32 v16, v16, s58, v20
    v_and_or_b32 v17, v17, s58, v21
    s_nop 0
    v_permlane32_swap_b32 v16, v18
    v_permlane32_swap_b32 v17, v19
    s_lshl_b32 s61, s4, 9
    s_add_u32 s61, s61, 458752
    s_add_u32 s61, s61, s54
    s_lshl4_add_u32 s14, s5, s61
    s_mov_b64 exec, 1
    s_cmp_lg_u32 s54, 0
    s_cbranch_scc1 L_sfar
    buffer_store_dwordx4 v[16:19], v6, s[40:43], s14 offen
    s_branch L_sdone
L_sfar:
    buffer_store_dwordx4 v[16:19], v6, s[40:43], s14 offen sc1
L_sdone:
    s_mov_b64 exec, -1
    s_cmp_ge_u32 s5, 28
    s_cbranch_scc1 L_end
    v_and_b32 v5, 31, v0
    v_lshlrev_b32 v5, 4, v5
    v_lshl_add_u32 v5, v4, 1, v5
    v_and_b32 v2, 3, v0
    v_lshlrev_b32 v2, 4, v2
    v_bfe_u32 v3, v0, 2, 2
    v_lshl_add_u32 v2, v3, 2, v2
    v_lshrrev_b32 v3, 4, v0
    v_lshl_add_u32 v2, v3, 6, v2
    s_waitcnt vmcnt(0)
L_ps:
    buffer_load_dwordx2 v[8:9], v5, s[40:43], s61 offen sc1 nt
    s_waitcnt vmcnt(0)
    v_xor_b32 v8, v20, v8
    v_xor_b32 v9, v21, v9
    v_or_b32 v12, v8, v9
    v_and_b32 v12, 0xff, v12
    v_cmp_ne_u32 vcc, 0, v12
    s_cbranch_vccnz L_rs
    v_mov_b32 v12, v8
    s_nop 1
    v_max_f32_dpp v12, v12, v12 row_ror:8 row_mask:0xf bank_mask:0xf
    s_nop 1
    v_max_f32_dpp v12, v12, v12 row_ror:4 row_mask:0xf bank_mask:0xf
    s_nop 1
    v_max_f32_dpp v12, v12, v12 row_ror:2 row_mask:0xf bank_mask:0xf
    s_nop 1
    v_max_f32_dpp v12, v12, v12 row_ror:1 row_mask:0xf bank_mask:0xf
    v_sub_f32 v8, v8, v12
    v_mul_f32 v8, s59, v8
    v_exp_f32 v8, v8
    s_nop 0
    v_mul_f32 v9, v9, v8
    s_nop 1
    v_add_f32_dpp v9, v9, v9 row_ror:8 row_mask:0xf bank_mask:0xf
    s_nop 1
    v_add_f32_dpp v9, v9, v9 row_ror:4 row_mask:0xf bank_mask:0xf
    s_nop 1
    v_add_f32_dpp v9, v9, v9 row_ror:2 row_mask:0xf bank_mask:0xf
    s_nop 1
    v_add_f32_dpp v9, v9, v9 row_ror:1 row_mask:0xf bank_mask:0xf
    v_rcp_f32 v10, v9
    s_nop 0
    v_fma_f32 v11, -v9, v10, 1.0
    v_fma_f32 v10, v11, v10, v10
    v_mul_f32 v8, v8, v10
    ds_write_b32 v2, v8 offset:3072
    v_mov_b32 v7, 1
    s_mov_b64 exec, 1
    ds_write_b32 v6, v7 offset:12
    s_waitcnt lgkmcnt(0)
    s_endpgm
L_rs:
    s_sleep 8
    s_sub_u32 s15, s15, 1
    s_cbranch_scc0 L_ps
    s_endpgm
L_pifail:
    s_sub_u32 s15, s15, 1
    s_cbranch_scc1 L_end
    s_sleep 8
    s_sub_u32 s63, s63, 1
    s_cmp_gt_i32 s63, 0
    s_cbranch_scc1 L_pi
    s_or_b32 s14, s60, 0x80
    v_mov_b32 v8, s14
    s_lshl_b32 s62, s4, 5
    s_cmp_lg_u32 s63, 0
    s_cbranch_scc1 L_piread
    s_add_u32 s14, s62, s5
    s_mov_b32 exec_lo, 1
    buffer_store_byte v8, v6, s[44:47], s14 offen sc1
    s_mov_b32 exec_lo, -1
L_piread:
    buffer_load_ubyte v3, v0, s[44:47], s62 offen sc1
    s_waitcnt vmcnt(0)
    v_cmp_eq_u32 vcc, 0, v3
    s_cbranch_vccnz L_pi
    v_cmp_ne_u32 vcc, v8, v3
    s_cmp_lg_u64 vcc, 0
    s_cselect_b32 s54, 1048576, 0
    s_branch L_pidone
L_end:
    s_endpgm
.section .rodata,"a"
.p2align 6
.amdhsa_kernel parallel_sum__sliding_block_cached__glu_gated_geglu__decode_kernel
  .amdhsa_next_free_vgpr 168
  .amdhsa_next_free_sgpr 96
  .amdhsa_accum_offset 168
  .amdhsa_group_segment_fixed_size 0
  .amdhsa_kernarg_size 96
  .amdhsa_user_sgpr_count 2
  .amdhsa_user_sgpr_kernarg_segment_ptr 1
  .amdhsa_system_sgpr_workgroup_id_x 1
.end_amdhsa_kernel
```
